```python
import torch

def _softmax(x, axis=-1):
    return torch.softmax(x, dim=axis)
def _gelu(x):
    return torch.nn.functional.gelu(x, approximate="tanh")
def _silu(x):
    return torch.nn.functional.silu(x)
def _sigmoid(x):
    return torch.sigmoid(x)
def _layernorm(x, axis=-1, eps=1e-5):
    m = x.mean(dim=axis, keepdim=True)
    v = x.var(dim=axis, keepdim=True, unbiased=False)
    return (x - m) / torch.sqrt(v + eps)
def _scatter_add(tgt, idx, src, axis=0):
    return tgt.clone().index_add_(axis, idx, src)
def _segment_sum(src, seg, n):
    out = torch.zeros((n,) + src.shape[1:], dtype=src.dtype)
    return out.index_add_(0, seg, src)
def _pad(x, pw):
    flat = tuple(v for pair in reversed(pw) for v in pair)
    return torch.nn.functional.pad(x, flat)

kernel_name = 'concat_heads__grouped_kv_mqa__ssm_conv_h3__prompt'

def setup_inputs():

    _w = (lambda a: (lambda t: t.to(torch.bfloat16) if t.is_floating_point() else t)(torch.as_tensor(a)))
    def _A_setup():
        B, S, D, H = 1, 2048, 576, 32
        Dh = D // H
        return {
            "x": _w((lambda *s: torch.randn(*s, dtype=torch.bfloat16) * 0.05)(B, S, D)),
            "wq": _w((lambda *s: torch.randn(*s, dtype=torch.bfloat16) * 0.8)(D, H * Dh)),
            "wk": _w((lambda *s: torch.randn(*s, dtype=torch.bfloat16) * 0.8)(D, Dh)),
            "wv": _w((lambda *s: torch.randn(*s, dtype=torch.bfloat16) * 0.05)(D, Dh)),
            "wo": _w((lambda *s: torch.randn(*s, dtype=torch.bfloat16) * 0.05)(H * Dh, D)),
        }
    _A_in = _A_setup()

    def _B_setup():
        B, S, D = 1, 2048, 576
        ks = 4
        return {
            "q": _w((lambda *s: torch.randn(*s, dtype=torch.bfloat16) * 0.05)(B, S, D)),
            "k": _w((lambda *s: torch.randn(*s, dtype=torch.bfloat16) * 0.2)(B, S, D)),
            "v": _w((lambda *s: torch.randn(*s, dtype=torch.bfloat16) * 0.2)(B, S, D)),
            "shift_k": _w((lambda *s: torch.randn(*s, dtype=torch.bfloat16) * 0.2)(D, ks) * 0.5),
            "ssm_k": _w((lambda *s: torch.randn(*s, dtype=torch.bfloat16) * 0.8)(D, S) * (1.0 / S ** 0.5)),
            "ssm_D": _w((lambda *s: torch.randn(*s, dtype=torch.bfloat16) * 0.2)(D)),
        }
    _B_in = _B_setup()

    return {
        "A_x": _A_in["x"],
        "A_wq": _A_in["wq"],
        "A_wk": _A_in["wk"],
        "A_wv": _A_in["wv"],
        "A_wo": _A_in["wo"],
        "B_q": _B_in["q"],
        "B_k": _B_in["k"],
        "B_v": _B_in["v"],
        "B_shift_k": _B_in["shift_k"],
        "B_ssm_k": _B_in["ssm_k"],
        "B_ssm_D": _B_in["ssm_D"],
    }

def reference(A_x, A_wq, A_wk, A_wv, A_wo, B_q, B_k, B_v, B_shift_k, B_ssm_k, B_ssm_D):
    def _A_ref(x, wq, wk, wv, wo):
        B, S, D = x.shape
        H = 32
        Dh = D // H
        q = (lambda x, *d: x.permute(*d))((x @ wq).reshape(B, S, H, Dh), 0, 2, 1, 3)
        k = x @ wk
        v = x @ wv
        scores = torch.einsum("bhqd,bkd->bhqk", q, k) * (Dh ** -0.5)
        p = _softmax(scores, axis=-1)
        o = torch.einsum("bhqk,bkd->bhqd", p, v)
        return (lambda x, *d: x.permute(*d))(o, 0, 2, 1, 3).reshape(B, S, H * Dh) @ wo

    def _B_ref(q, k, v, shift_k, ssm_k, ssm_D):
        B, S, D = q.shape
        ks = shift_k.shape[-1]
        k_pad = _pad(k, ((0, 0), (ks - 1, 0), (0, 0)))
        k_shift = torch.zeros_like(k)
        for t in range(ks):
            k_shift = k_shift + k_pad[:, t:t + S, :] * shift_k[:, ks - 1 - t][None, None, :]
        kv = k_shift * v
        L = 2 * S
        kv_pad = _pad(kv, ((0, 0), (0, S), (0, 0)))
        kf_pad = _pad(ssm_k, ((0, 0), (0, S)))
        kv_f = (lambda x, axes=(-2,-1): torch.fft.rfft2(x.float(), dim=axes))(kv_pad[:, None, :, :], axes=(1, 2))
        kf_f = (lambda x, axes=(-2,-1): torch.fft.rfft2(x.float(), dim=axes))(kf_pad[:, None, :], axes=(1, 2))
        kf_f = (lambda x, *d: x.permute(*d))(kf_f, 1, 2, 0)
        y_f = kv_f * kf_f[None, :, :, :]
        y = (lambda x, s, axes=(-2,-1): torch.fft.irfft2(x, s=s, dim=axes).to(torch.bfloat16))(y_f, (1, L), axes=(1, 2))[:, 0, :S, :]
        y = y + kv * ssm_D[None, None, :]
        return q * y

    a = _A_ref(A_x, A_wq, A_wk, A_wv, A_wo)
    b = _B_ref(B_q, B_k, B_v, B_shift_k, B_ssm_k, B_ssm_D)
    return torch.concatenate([a, b], axis=-1)
```

```asm
; @launch grid=(256,1,1) block=(832,1,1) lds=163840
.amdgcn_target "amdgcn-amd-amdhsa--gfx950"
.text
.globl concat_heads__grouped_kv_mqa__ssm_conv_h3__prompt_kernel
.p2align 8
.type concat_heads__grouped_kv_mqa__ssm_conv_h3__prompt_kernel,@function
concat_heads__grouped_kv_mqa__ssm_conv_h3__prompt_kernel:
    s_cmp_ge_u32 s2, 256
    s_cbranch_scc1 L_exit
    s_load_dwordx16 s[36:51], s[0:1], 0
    s_load_dwordx8 s[52:59], s[0:1], 64
    s_load_dwordx4 s[60:63], s[0:1], 96
    s_getpc_b64 s[10:11]
L_pc0:
    s_bfe_u32 s12, s2, 0x40003
    s_lshl_b32 s12, s12, 11
    s_sub_u32 s12, s12, L_pc0-concat_heads__grouped_kv_mqa__ssm_conv_h3__prompt_kernel
    v_lshlrev_b32 v5, 7, v0
    v_add_u32 v5, s12, v5
    v_cmp_gt_u32 vcc, 16, v0
    v_min_i32 v5, L_exit-L_pc0, v5
    s_and_saveexec_b64 s[14:15], vcc
    s_cbranch_execz L_nopf0
    v_ashrrev_i32 v7, 31, v5
    v_add_co_u32 v6, vcc, s10, v5
    v_mov_b32 v8, s11
    s_nop 0
    v_addc_co_u32 v7, vcc, v8, v7, vcc
    global_load_dword v127, v[6:7], off
L_nopf0:
    s_mov_b64 exec, s[14:15]
    v_lshrrev_b32 v4, 6, v0
    v_and_b32 v1, 63, v0
    v_mov_b32 v2, 163584
    v_mov_b32 v3, 1
    v_readfirstlane_b32 s4, v4
    v_lshlrev_b32 v5, 2, v1
    v_add_u32 v5, 163584, v5
    v_mov_b32 v6, 0
    s_cmp_lg_u32 s4, 12
    s_cbranch_scc1 L_nz
    ds_write_b32 v5, v6
L_nz:
    s_and_b32 s5, s2, 7
    s_lshl_b32 s5, s5, 2
    s_bfe_u32 s10, s2, 0x20003
    s_add_u32 s5, s5, s10
    s_lshr_b32 s6, s2, 5
    s_and_b32 s10, s5, 1
    s_lshl_b32 s10, s10, 2
    s_sub_u32 s7, s6, s10
    s_min_u32 s7, s7, 4
    s_mov_b32 s8, 0x100000
    s_mov_b32 s9, 0
    s_waitcnt lgkmcnt(0)
    s_mov_b32 s20, s62
    s_mov_b32 s21, s63
    s_mov_b32 s22, 8388608
    s_mov_b32 s23, 0x20000
    s_cmp_ge_u32 s4, 12
    s_cbranch_scc1 L_loader
    s_cmp_ge_u32 s4, 8
    s_cbranch_scc1 L_bteam
    s_mov_b32 s24, s36
    s_mov_b32 s25, s37
    s_mov_b32 s26, 2359296
    s_mov_b32 s27, 0x20000
    s_and_b32 s72, s4, 3
    s_lshr_b32 s73, s4, 2
    s_lshl_b32 s10, s5, 6
    s_lshl_b32 s11, s4, 3
    s_add_u32 s10, s10, s11
    v_lshrrev_b32 v104, 3, v1
    v_add_u32 v104, s10, v104
    v_mul_u32_u24 v104, 1152, v104
    s_and_b32 s11, s4, 1
    s_lshl_b32 s11, s11, 2
    v_lshrrev_b32 v105, 4, v1
    v_add_u32 v105, s11, v105
    v_and_b32 v106, 7, v1
    v_xor_b32 v105, v105, v106
    v_lshl_add_u32 v5, v105, 4, v104
    s_mul_i32 s12, s4, 9216
    s_and_b32 s10, s7, 1
    s_cmp_lg_u32 s10, s73
    s_cselect_b32 s15, 1, 0
    s_cmp_lt_u32 s7, 4
    s_cselect_b32 s15, s15, 0
    s_cmp_lg_u32 s15, 0
    s_cbranch_scc1 L_a_xlate
    s_add_u32 m0, s12, 0
    s_nop 0
    buffer_load_dwordx4 v5, s[24:27], 0 offen lds
    s_add_u32 m0, s12, 896
    s_nop 0
    buffer_load_dwordx4 v5, s[24:27], 0 offen offset:128 lds
    s_add_u32 m0, s12, 1792
    s_nop 0
    buffer_load_dwordx4 v5, s[24:27], 0 offen offset:256 lds
    s_add_u32 m0, s12, 2688
    s_nop 0
    buffer_load_dwordx4 v5, s[24:27], 0 offen offset:384 lds
    s_add_u32 m0, s12, 3584
    s_nop 0
    buffer_load_dwordx4 v5, s[24:27], 0 offen offset:512 lds
    s_add_u32 m0, s12, 4480
    s_nop 0
    buffer_load_dwordx4 v5, s[24:27], 0 offen offset:640 lds
    s_add_u32 m0, s12, 5376
    s_nop 0
    buffer_load_dwordx4 v5, s[24:27], 0 offen offset:768 lds
    s_add_u32 m0, s12, 6272
    s_nop 0
    buffer_load_dwordx4 v5, s[24:27], 0 offen offset:896 lds
    s_add_u32 m0, s12, 7168
    s_nop 0
    buffer_load_dwordx4 v5, s[24:27], 0 offen offset:1024 lds
L_a_xlate:
    s_barrier
    s_cmp_lg_u32 s15, 0
    s_cbranch_scc1 L_a_xl2
    s_mov_b64 exec, 1
    ds_add_u32 v2, v3 offset:108
    s_mov_b64 exec, -1
    s_cmp_lt_u32 s7, 4
    s_cbranch_scc0 L_a_xl2
    s_waitcnt vmcnt(6)
    s_mov_b64 exec, 1
    ds_add_u32 v2, v3 offset:0
    s_mov_b64 exec, -1
    s_waitcnt vmcnt(3)
    s_mov_b64 exec, 1
    ds_add_u32 v2, v3 offset:4
    s_mov_b64 exec, -1
    s_waitcnt vmcnt(0)
    s_mov_b64 exec, 1
    ds_add_u32 v2, v3 offset:8
    s_mov_b64 exec, -1
L_a_xl2:
    s_branch L_a_rest
L_bteam:
    s_setprio 3
    s_sub_u32 s72, s4, 8
    s_cmp_ge_u32 s7, 4
    s_cbranch_scc1 L_b_nojob0
    s_cmp_lt_u32 s7, 2
    s_cselect_b32 s24, s40, s42
    s_cselect_b32 s25, s41, s43
    s_mov_b32 s26, 20736
    s_mov_b32 s27, 0x20000
    v_add_u32 v8, 0, v1
    v_mul_u32_u24 v9, 21846, v8
    v_lshrrev_b32 v9, 16, v9
    v_mul_u32_u24 v10, 3, v9
    v_sub_u32 v10, v8, v10
    v_mul_u32_u24 v9, 36, v9
    v_lshl_add_u32 v12, v10, 4, v9
    v_add_u32 v8, 64, v1
    v_mul_u32_u24 v9, 21846, v8
    v_lshrrev_b32 v9, 16, v9
    v_mul_u32_u24 v10, 3, v9
    v_sub_u32 v10, v8, v10
    v_mul_u32_u24 v9, 36, v9
    v_lshl_add_u32 v13, v10, 4, v9
    v_add_u32 v8, 128, v1
    v_mul_u32_u24 v9, 21846, v8
    v_lshrrev_b32 v9, 16, v9
    v_mul_u32_u24 v10, 3, v9
    v_sub_u32 v10, v8, v10
    v_mul_u32_u24 v9, 36, v9
    v_lshl_add_u32 v14, v10, 4, v9
    s_add_u32 s10, s72, 0
    s_mul_i32 s11, s10, 2304
    s_mul_i32 s10, s10, 3072
    s_add_u32 m0, s10, 129024
    s_nop 0
    buffer_load_dwordx4 v12, s[24:27], s11 offen lds
    s_add_u32 m0, s10, 130048
    s_nop 0
    buffer_load_dwordx4 v13, s[24:27], s11 offen lds
    s_add_u32 m0, s10, 131072
    s_nop 0
    buffer_load_dwordx4 v14, s[24:27], s11 offen lds
    s_add_u32 s10, s72, 4
    s_mul_i32 s11, s10, 2304
    s_mul_i32 s10, s10, 3072
    s_add_u32 m0, s10, 129024
    s_nop 0
    buffer_load_dwordx4 v12, s[24:27], s11 offen lds
    s_add_u32 m0, s10, 130048
    s_nop 0
    buffer_load_dwordx4 v13, s[24:27], s11 offen lds
    s_add_u32 m0, s10, 131072
    s_nop 0
    buffer_load_dwordx4 v14, s[24:27], s11 offen lds
    s_cmp_lg_u32 s72, 0
    s_cbranch_scc1 L_b_wk3
    s_add_u32 s10, s72, 8
    s_mul_i32 s11, s10, 2304
    s_mul_i32 s10, s10, 3072
    s_add_u32 m0, s10, 129024
    s_nop 0
    buffer_load_dwordx4 v12, s[24:27], s11 offen lds
    s_add_u32 m0, s10, 130048
    s_nop 0
    buffer_load_dwordx4 v13, s[24:27], s11 offen lds
    s_add_u32 m0, s10, 131072
    s_nop 0
    buffer_load_dwordx4 v14, s[24:27], s11 offen lds
L_b_wk3:
    s_barrier
    s_mov_b64 exec, 1
    ds_add_u32 v2, v3 offset:108
    s_mov_b64 exec, -1
    s_branch L_b_rest
L_loader:
    s_setprio 3
    s_mov_b32 s68, s60
    s_mov_b32 s69, s61
    s_mov_b32 s70, 256
    s_mov_b32 s71, 0x20000
    s_mov_b32 s28, s38
    s_mov_b32 s29, s39
    s_mov_b32 s30, 663552
    s_mov_b32 s31, 0x20000
    s_mov_b32 s24, s44
    s_mov_b32 s25, s45
    s_mov_b32 s26, 663552
    s_mov_b32 s27, 0x20000
    v_mov_b32 v18, 0
    v_lshlrev_b32 v5, 7, v1
    s_cmp_lg_u32 s2, 0
    s_cbranch_scc1 L_l_n1
    s_memrealtime s[10:11]
    s_waitcnt lgkmcnt(0)
    s_or_b32 s10, s10, 1
    v_mov_b32 v17, s10
    s_mov_b64 exec, 1
    buffer_store_dword v17, v18, s[68:71], 0 offen sc1
    s_mov_b64 exec, -1
    s_branch L_l_n2
L_l_n1:
    buffer_load_dword v17, v18, s[68:71], 0 offen sc1
L_l_n2:
    s_barrier
    v_add_u32 v6, 0, v1
    v_mul_u32_u24 v7, 7282, v6
    v_lshrrev_b32 v7, 16, v7
    v_mul_u32_u24 v8, 9, v7
    v_sub_u32 v8, v6, v8
    v_and_b32 v9, 3, v7
    v_max_u32 v9, 1, v9
    v_sub_u32 v8, v8, v9
    v_add_u32 v8, 1, v8
    v_add_u32 v9, 9, v8
    v_min_u32 v8, v8, v9
    v_mul_u32_u24 v7, 1152, v7
    v_lshl_add_u32 v20, v8, 4, v7
    v_add_u32 v6, 64, v1
    v_mul_u32_u24 v7, 7282, v6
    v_lshrrev_b32 v7, 16, v7
    v_mul_u32_u24 v8, 9, v7
    v_sub_u32 v8, v6, v8
    v_and_b32 v9, 3, v7
    v_max_u32 v9, 1, v9
    v_sub_u32 v8, v8, v9
    v_add_u32 v8, 1, v8
    v_add_u32 v9, 9, v8
    v_min_u32 v8, v8, v9
    v_mul_u32_u24 v7, 1152, v7
    v_lshl_add_u32 v21, v8, 4, v7
    v_add_u32 v6, 128, v1
    v_mul_u32_u24 v7, 7282, v6
    v_lshrrev_b32 v7, 16, v7
    v_mul_u32_u24 v8, 9, v7
    v_sub_u32 v8, v6, v8
    v_and_b32 v9, 3, v7
    v_max_u32 v9, 1, v9
    v_sub_u32 v8, v8, v9
    v_add_u32 v8, 1, v8
    v_add_u32 v9, 9, v8
    v_min_u32 v8, v8, v9
    v_mul_u32_u24 v7, 1152, v7
    v_lshl_add_u32 v22, v8, 4, v7
    v_add_u32 v6, 192, v1
    v_mul_u32_u24 v7, 7282, v6
    v_lshrrev_b32 v7, 16, v7
    v_mul_u32_u24 v8, 9, v7
    v_sub_u32 v8, v6, v8
    v_and_b32 v9, 3, v7
    v_max_u32 v9, 1, v9
    v_sub_u32 v8, v8, v9
    v_add_u32 v8, 1, v8
    v_add_u32 v9, 9, v8
    v_min_u32 v8, v8, v9
    v_mul_u32_u24 v7, 1152, v7
    v_lshl_add_u32 v23, v8, 4, v7
    v_add_u32 v6, 256, v1
    v_mul_u32_u24 v7, 7282, v6
    v_lshrrev_b32 v7, 16, v7
    v_mul_u32_u24 v8, 9, v7
    v_sub_u32 v8, v6, v8
    v_and_b32 v9, 3, v7
    v_max_u32 v9, 1, v9
    v_sub_u32 v8, v8, v9
    v_add_u32 v8, 1, v8
    v_add_u32 v9, 9, v8
    v_min_u32 v8, v8, v9
    v_mul_u32_u24 v7, 1152, v7
    v_lshl_add_u32 v24, v8, 4, v7
    v_add_u32 v6, 320, v1
    v_mul_u32_u24 v7, 7282, v6
    v_lshrrev_b32 v7, 16, v7
    v_mul_u32_u24 v8, 9, v7
    v_sub_u32 v8, v6, v8
    v_and_b32 v9, 3, v7
    v_max_u32 v9, 1, v9
    v_sub_u32 v8, v8, v9
    v_add_u32 v8, 1, v8
    v_add_u32 v9, 9, v8
    v_min_u32 v8, v8, v9
    v_mul_u32_u24 v7, 1152, v7
    v_lshl_add_u32 v25, v8, 4, v7
    v_add_u32 v6, 384, v1
    v_mul_u32_u24 v7, 7282, v6
    v_lshrrev_b32 v7, 16, v7
    v_mul_u32_u24 v8, 9, v7
    v_sub_u32 v8, v6, v8
    v_and_b32 v9, 3, v7
    v_max_u32 v9, 1, v9
    v_sub_u32 v8, v8, v9
    v_add_u32 v8, 1, v8
    v_add_u32 v9, 9, v8
    v_min_u32 v8, v8, v9
    v_mul_u32_u24 v7, 1152, v7
    v_lshl_add_u32 v26, v8, 4, v7
    v_add_u32 v6, 448, v1
    v_mul_u32_u24 v7, 7282, v6
    v_lshrrev_b32 v7, 16, v7
    v_mul_u32_u24 v8, 9, v7
    v_sub_u32 v8, v6, v8
    v_and_b32 v9, 3, v7
    v_max_u32 v9, 1, v9
    v_sub_u32 v8, v8, v9
    v_add_u32 v8, 1, v8
    v_add_u32 v9, 9, v8
    v_min_u32 v8, v8, v9
    v_mul_u32_u24 v7, 1152, v7
    v_lshl_add_u32 v27, v8, 4, v7
    v_add_u32 v6, 512, v1
    v_mul_u32_u24 v7, 7282, v6
    v_lshrrev_b32 v7, 16, v7
    v_mul_u32_u24 v8, 9, v7
    v_sub_u32 v8, v6, v8
    v_and_b32 v9, 3, v7
    v_max_u32 v9, 1, v9
    v_sub_u32 v8, v8, v9
    v_add_u32 v8, 1, v8
    v_add_u32 v9, 9, v8
    v_min_u32 v8, v8, v9
    v_mul_u32_u24 v7, 1152, v7
    v_lshl_add_u32 v28, v8, 4, v7
    s_mul_i32 s12, s6, 144
    v_mov_b32 v6, 2
    v_mov_b32 v7, 3
    s_cmp_lt_u32 s7, 4
    s_cbranch_scc0 L_l_nkv
W_89:
    ds_read_b32 v4, v2 offset:108
    s_waitcnt lgkmcnt(0)
    v_readfirstlane_b32 s3, v4
    s_cmp_ge_u32 s3, 8
    s_cbranch_scc1 WD_90
    s_sub_u32 s8, s8, 1
    s_cselect_b32 s8, 0, s8
    s_cbranch_scc1 WD_90
    s_sleep 0
    s_branch W_89
WD_90:
    s_bfe_u32 s11, s2, 0x20003
    s_lshl_b32 s11, s11, 2
    s_add_u32 s11, s11, s7
    s_mul_i32 s10, s11, 27648
    s_add_u32 s10, s10, 221184
    buffer_load_dword v44, v5, s[28:31], s10 offen
    s_add_u32 s10, s10, 8192
    buffer_load_dword v45, v5, s[28:31], s10 offen
    s_add_u32 s10, s10, 8192
    buffer_load_dword v46, v5, s[28:31], s10 offen
    s_add_u32 s10, s10, 8192
    s_mov_b64 exec, 0xffffff
    buffer_load_dword v49, v5, s[28:31], s10 offen
    s_mov_b64 exec, 0xffff
    s_getpc_b64 s[14:15]
L_pc:
    s_sub_u32 s14, s14, L_pc-concat_heads__grouped_kv_mqa__ssm_conv_h3__prompt_kernel
    s_subb_u32 s15, s15, 0
    s_mul_i32 s11, s11, 2048
    v_add_u32 v8, s11, v5
    v_min_u32 v8, L_exit-concat_heads__grouped_kv_mqa__ssm_conv_h3__prompt_kernel, v8
    global_load_dword v50, v8, s[14:15]
    s_mov_b64 exec, -1
    s_mov_b64 exec, 1
    ds_add_u32 v2, v3 offset:108
    s_mov_b64 exec, -1
    s_waitcnt vmcnt(5)
    s_cmp_lg_u32 s9, 0
    s_cbranch_scc1 NT_91
NL_92:
    v_readfirstlane_b32 s9, v17
    s_cmp_lg_u32 s9, 0
    s_cbranch_scc1 NG_93
    s_sub_u32 s8, s8, 16
    s_cselect_b32 s8, 0, s8
    s_cbranch_scc1 NG_93
    buffer_load_dword v17, v18, s[68:71], 0 offen sc1
    s_waitcnt vmcnt(0)
    s_branch NL_92
NG_93:
    v_or_b32 v17, 1, v17
    s_or_b32 s9, s9, 1
    ds_write_b32 v2, v17 offset:44
NT_91:
W_94:
    ds_read_b32 v4, v2 offset:8
    s_waitcnt lgkmcnt(0)
    v_readfirstlane_b32 s3, v4
    s_cmp_ge_u32 s3, 4
    s_cbranch_scc1 WD_95
    s_sub_u32 s8, s8, 1
    s_cselect_b32 s8, 0, s8
    s_cbranch_scc1 WD_95
    s_sleep 0
    s_branch W_94
WD_95:
    s_add_u32 s13, s12, 0
    s_mov_b32 m0, 101376
    s_nop 0
    buffer_load_dwordx4 v20, s[28:31], s13 offen lds
    s_mov_b32 m0, 102400
    s_nop 0
    buffer_load_dwordx4 v21, s[28:31], s13 offen lds
    s_mov_b32 m0, 103424
    s_nop 0
    buffer_load_dwordx4 v22, s[28:31], s13 offen lds
    s_mov_b32 m0, 104448
    s_nop 0
    buffer_load_dwordx4 v23, s[28:31], s13 offen lds
    s_mov_b32 m0, 105472
    s_nop 0
    buffer_load_dwordx4 v24, s[28:31], s13 offen lds
    s_mov_b32 m0, 106496
    s_nop 0
    buffer_load_dwordx4 v25, s[28:31], s13 offen lds
    s_mov_b32 m0, 107520
    s_nop 0
    buffer_load_dwordx4 v26, s[28:31], s13 offen lds
    s_mov_b32 m0, 108544
    s_nop 0
    buffer_load_dwordx4 v27, s[28:31], s13 offen lds
    s_mov_b32 m0, 109568
    s_nop 0
    buffer_load_dwordx4 v28, s[28:31], s13 offen lds
    s_add_u32 s13, s12, 73728
    s_mov_b32 m0, 110592
    s_nop 0
    buffer_load_dwordx4 v20, s[28:31], s13 offen lds
    s_mov_b32 m0, 111616
    s_nop 0
    buffer_load_dwordx4 v21, s[28:31], s13 offen lds
    s_mov_b32 m0, 112640
    s_nop 0
    buffer_load_dwordx4 v22, s[28:31], s13 offen lds
    s_mov_b32 m0, 113664
    s_nop 0
    buffer_load_dwordx4 v23, s[28:31], s13 offen lds
    s_mov_b32 m0, 114688
    s_nop 0
    buffer_load_dwordx4 v24, s[28:31], s13 offen lds
    s_mov_b32 m0, 115712
    s_nop 0
    buffer_load_dwordx4 v25, s[28:31], s13 offen lds
    s_mov_b32 m0, 116736
    s_nop 0
    buffer_load_dwordx4 v26, s[28:31], s13 offen lds
    s_mov_b32 m0, 117760
    s_nop 0
    buffer_load_dwordx4 v27, s[28:31], s13 offen lds
    s_mov_b32 m0, 118784
    s_nop 0
    buffer_load_dwordx4 v28, s[28:31], s13 offen lds
    s_add_u32 s13, s12, 147456
    s_mov_b32 m0, 119808
    s_nop 0
    buffer_load_dwordx4 v20, s[28:31], s13 offen lds
    s_mov_b32 m0, 120832
    s_nop 0
    buffer_load_dwordx4 v21, s[28:31], s13 offen lds
    s_mov_b32 m0, 121856
    s_nop 0
    buffer_load_dwordx4 v22, s[28:31], s13 offen lds
    s_mov_b32 m0, 122880
    s_nop 0
    buffer_load_dwordx4 v23, s[28:31], s13 offen lds
    s_mov_b32 m0, 123904
    s_nop 0
    buffer_load_dwordx4 v24, s[28:31], s13 offen lds
    s_mov_b32 m0, 124928
    s_nop 0
    buffer_load_dwordx4 v25, s[28:31], s13 offen lds
    s_mov_b32 m0, 125952
    s_nop 0
    buffer_load_dwordx4 v26, s[28:31], s13 offen lds
    s_mov_b32 m0, 126976
    s_nop 0
    buffer_load_dwordx4 v27, s[28:31], s13 offen lds
    s_mov_b32 m0, 128000
    s_nop 0
    buffer_load_dwordx4 v28, s[28:31], s13 offen lds
    s_add_u32 s13, s12, 221184
    s_mov_b32 m0, 73728
    s_nop 0
    buffer_load_dwordx4 v20, s[28:31], s13 offen lds
    s_mov_b32 m0, 74752
    s_nop 0
    buffer_load_dwordx4 v21, s[28:31], s13 offen lds
    s_mov_b32 m0, 75776
    s_nop 0
    buffer_load_dwordx4 v22, s[28:31], s13 offen lds
    s_mov_b32 m0, 76800
    s_nop 0
    buffer_load_dwordx4 v23, s[28:31], s13 offen lds
    s_mov_b32 m0, 77824
    s_nop 0
    buffer_load_dwordx4 v24, s[28:31], s13 offen lds
    s_mov_b32 m0, 78848
    s_nop 0
    buffer_load_dwordx4 v25, s[28:31], s13 offen lds
    s_mov_b32 m0, 79872
    s_nop 0
    buffer_load_dwordx4 v26, s[28:31], s13 offen lds
    s_mov_b32 m0, 80896
    s_nop 0
    buffer_load_dwordx4 v27, s[28:31], s13 offen lds
    s_mov_b32 m0, 81920
    s_nop 0
    buffer_load_dwordx4 v28, s[28:31], s13 offen lds
    s_add_u32 s13, s12, 294912
    s_mov_b32 m0, 82944
    s_nop 0
    buffer_load_dwordx4 v20, s[28:31], s13 offen lds
    s_mov_b32 m0, 83968
    s_nop 0
    buffer_load_dwordx4 v21, s[28:31], s13 offen lds
    s_mov_b32 m0, 84992
    s_nop 0
    buffer_load_dwordx4 v22, s[28:31], s13 offen lds
    s_mov_b32 m0, 86016
    s_nop 0
    buffer_load_dwordx4 v23, s[28:31], s13 offen lds
    s_mov_b32 m0, 87040
    s_nop 0
    buffer_load_dwordx4 v24, s[28:31], s13 offen lds
    s_mov_b32 m0, 88064
    s_nop 0
    buffer_load_dwordx4 v25, s[28:31], s13 offen lds
    s_mov_b32 m0, 89088
    s_nop 0
    buffer_load_dwordx4 v26, s[28:31], s13 offen lds
    s_mov_b32 m0, 90112
    s_nop 0
    buffer_load_dwordx4 v27, s[28:31], s13 offen lds
    s_mov_b32 m0, 91136
    s_nop 0
    buffer_load_dwordx4 v28, s[28:31], s13 offen lds
    s_add_u32 s13, s12, 368640
    s_mov_b32 m0, 92160
    s_nop 0
    buffer_load_dwordx4 v20, s[28:31], s13 offen lds
    s_mov_b32 m0, 93184
    s_nop 0
    buffer_load_dwordx4 v21, s[28:31], s13 offen lds
    s_mov_b32 m0, 94208
    s_nop 0
    buffer_load_dwordx4 v22, s[28:31], s13 offen lds
    s_mov_b32 m0, 95232
    s_nop 0
    buffer_load_dwordx4 v23, s[28:31], s13 offen lds
    s_mov_b32 m0, 96256
    s_nop 0
    buffer_load_dwordx4 v24, s[28:31], s13 offen lds
    s_mov_b32 m0, 97280
    s_nop 0
    buffer_load_dwordx4 v25, s[28:31], s13 offen lds
    s_mov_b32 m0, 98304
    s_nop 0
    buffer_load_dwordx4 v26, s[28:31], s13 offen lds
    s_mov_b32 m0, 99328
    s_nop 0
    buffer_load_dwordx4 v27, s[28:31], s13 offen lds
    s_mov_b32 m0, 100352
    s_nop 0
    buffer_load_dwordx4 v28, s[28:31], s13 offen lds
W_96:
    ds_read_b32 v4, v2 offset:24
    s_waitcnt lgkmcnt(0)
    v_readfirstlane_b32 s3, v4
    s_cmp_ge_u32 s3, 1
    s_cbranch_scc1 WD_97
    s_sub_u32 s8, s8, 1
    s_cselect_b32 s8, 0, s8
    s_cbranch_scc1 WD_97
    s_sleep 0
    s_branch W_96
WD_97:
    s_waitcnt vmcnt(54)
    s_add_u32 s13, s12, 442368
    s_mov_b32 m0, 129024
    s_nop 0
    buffer_load_dwordx4 v20, s[28:31], s13 offen lds
    s_mov_b32 m0, 130048
    s_nop 0
    buffer_load_dwordx4 v21, s[28:31], s13 offen lds
    s_mov_b32 m0, 131072
    s_nop 0
    buffer_load_dwordx4 v22, s[28:31], s13 offen lds
    s_mov_b32 m0, 132096
    s_nop 0
    buffer_load_dwordx4 v23, s[28:31], s13 offen lds
    s_mov_b32 m0, 133120
    s_nop 0
    buffer_load_dwordx4 v24, s[28:31], s13 offen lds
    s_mov_b32 m0, 134144
    s_nop 0
    buffer_load_dwordx4 v25, s[28:31], s13 offen lds
    s_mov_b32 m0, 135168
    s_nop 0
    buffer_load_dwordx4 v26, s[28:31], s13 offen lds
    s_mov_b32 m0, 136192
    s_nop 0
    buffer_load_dwordx4 v27, s[28:31], s13 offen lds
    s_mov_b32 m0, 137216
    s_nop 0
    buffer_load_dwordx4 v28, s[28:31], s13 offen lds
    s_waitcnt vmcnt(54)
    s_add_u32 s13, s12, 516096
    s_mov_b32 m0, 138240
    s_nop 0
    buffer_load_dwordx4 v20, s[28:31], s13 offen lds
    s_mov_b32 m0, 139264
    s_nop 0
    buffer_load_dwordx4 v21, s[28:31], s13 offen lds
    s_mov_b32 m0, 140288
    s_nop 0
    buffer_load_dwordx4 v22, s[28:31], s13 offen lds
    s_mov_b32 m0, 141312
    s_nop 0
    buffer_load_dwordx4 v23, s[28:31], s13 offen lds
    s_mov_b32 m0, 142336
    s_nop 0
    buffer_load_dwordx4 v24, s[28:31], s13 offen lds
    s_mov_b32 m0, 143360
    s_nop 0
    buffer_load_dwordx4 v25, s[28:31], s13 offen lds
    s_mov_b32 m0, 144384
    s_nop 0
    buffer_load_dwordx4 v26, s[28:31], s13 offen lds
    s_mov_b32 m0, 145408
    s_nop 0
    buffer_load_dwordx4 v27, s[28:31], s13 offen lds
    s_mov_b32 m0, 146432
    s_nop 0
    buffer_load_dwordx4 v28, s[28:31], s13 offen lds
    s_waitcnt vmcnt(54)
    s_add_u32 s13, s12, 589824
    s_mov_b32 m0, 147456
    s_nop 0
    buffer_load_dwordx4 v20, s[28:31], s13 offen lds
    s_mov_b32 m0, 148480
    s_nop 0
    buffer_load_dwordx4 v21, s[28:31], s13 offen lds
    s_mov_b32 m0, 149504
    s_nop 0
    buffer_load_dwordx4 v22, s[28:31], s13 offen lds
    s_mov_b32 m0, 150528
    s_nop 0
    buffer_load_dwordx4 v23, s[28:31], s13 offen lds
    s_mov_b32 m0, 151552
    s_nop 0
    buffer_load_dwordx4 v24, s[28:31], s13 offen lds
    s_mov_b32 m0, 152576
    s_nop 0
    buffer_load_dwordx4 v25, s[28:31], s13 offen lds
    s_mov_b32 m0, 153600
    s_nop 0
    buffer_load_dwordx4 v26, s[28:31], s13 offen lds
    s_mov_b32 m0, 154624
    s_nop 0
    buffer_load_dwordx4 v27, s[28:31], s13 offen lds
    s_mov_b32 m0, 155648
    s_nop 0
    buffer_load_dwordx4 v28, s[28:31], s13 offen lds
    ds_write_b32 v2, v3 offset:112
    s_waitcnt vmcnt(54)
    ds_write_b32 v2, v3 offset:20
    s_branch L_l_wq2
L_l_nkv:
    s_add_u32 s13, s12, 0
    s_mov_b32 m0, 101376
    s_nop 0
    buffer_load_dwordx4 v20, s[28:31], s13 offen lds
    s_mov_b32 m0, 102400
    s_nop 0
    buffer_load_dwordx4 v21, s[28:31], s13 offen lds
    s_mov_b32 m0, 103424
    s_nop 0
    buffer_load_dwordx4 v22, s[28:31], s13 offen lds
    s_mov_b32 m0, 104448
    s_nop 0
    buffer_load_dwordx4 v23, s[28:31], s13 offen lds
    s_mov_b32 m0, 105472
    s_nop 0
    buffer_load_dwordx4 v24, s[28:31], s13 offen lds
    s_mov_b32 m0, 106496
    s_nop 0
    buffer_load_dwordx4 v25, s[28:31], s13 offen lds
    s_mov_b32 m0, 107520
    s_nop 0
    buffer_load_dwordx4 v26, s[28:31], s13 offen lds
    s_mov_b32 m0, 108544
    s_nop 0
    buffer_load_dwordx4 v27, s[28:31], s13 offen lds
    s_mov_b32 m0, 109568
    s_nop 0
    buffer_load_dwordx4 v28, s[28:31], s13 offen lds
    s_add_u32 s13, s12, 73728
    s_mov_b32 m0, 110592
    s_nop 0
    buffer_load_dwordx4 v20, s[28:31], s13 offen lds
    s_mov_b32 m0, 111616
    s_nop 0
    buffer_load_dwordx4 v21, s[28:31], s13 offen lds
    s_mov_b32 m0, 112640
    s_nop 0
    buffer_load_dwordx4 v22, s[28:31], s13 offen lds
    s_mov_b32 m0, 113664
    s_nop 0
    buffer_load_dwordx4 v23, s[28:31], s13 offen lds
    s_mov_b32 m0, 114688
    s_nop 0
    buffer_load_dwordx4 v24, s[28:31], s13 offen lds
    s_mov_b32 m0, 115712
    s_nop 0
    buffer_load_dwordx4 v25, s[28:31], s13 offen lds
    s_mov_b32 m0, 116736
    s_nop 0
    buffer_load_dwordx4 v26, s[28:31], s13 offen lds
    s_mov_b32 m0, 117760
    s_nop 0
    buffer_load_dwordx4 v27, s[28:31], s13 offen lds
    s_mov_b32 m0, 118784
    s_nop 0
    buffer_load_dwordx4 v28, s[28:31], s13 offen lds
    s_add_u32 s13, s12, 147456
    s_mov_b32 m0, 119808
    s_nop 0
    buffer_load_dwordx4 v20, s[28:31], s13 offen lds
    s_mov_b32 m0, 120832
    s_nop 0
    buffer_load_dwordx4 v21, s[28:31], s13 offen lds
    s_mov_b32 m0, 121856
    s_nop 0
    buffer_load_dwordx4 v22, s[28:31], s13 offen lds
    s_mov_b32 m0, 122880
    s_nop 0
    buffer_load_dwordx4 v23, s[28:31], s13 offen lds
    s_mov_b32 m0, 123904
    s_nop 0
    buffer_load_dwordx4 v24, s[28:31], s13 offen lds
    s_mov_b32 m0, 124928
    s_nop 0
    buffer_load_dwordx4 v25, s[28:31], s13 offen lds
    s_mov_b32 m0, 125952
    s_nop 0
    buffer_load_dwordx4 v26, s[28:31], s13 offen lds
    s_mov_b32 m0, 126976
    s_nop 0
    buffer_load_dwordx4 v27, s[28:31], s13 offen lds
    s_mov_b32 m0, 128000
    s_nop 0
    buffer_load_dwordx4 v28, s[28:31], s13 offen lds
    s_add_u32 s13, s12, 221184
    s_mov_b32 m0, 73728
    s_nop 0
    buffer_load_dwordx4 v20, s[28:31], s13 offen lds
    s_mov_b32 m0, 74752
    s_nop 0
    buffer_load_dwordx4 v21, s[28:31], s13 offen lds
    s_mov_b32 m0, 75776
    s_nop 0
    buffer_load_dwordx4 v22, s[28:31], s13 offen lds
    s_mov_b32 m0, 76800
    s_nop 0
    buffer_load_dwordx4 v23, s[28:31], s13 offen lds
    s_mov_b32 m0, 77824
    s_nop 0
    buffer_load_dwordx4 v24, s[28:31], s13 offen lds
    s_mov_b32 m0, 78848
    s_nop 0
    buffer_load_dwordx4 v25, s[28:31], s13 offen lds
    s_mov_b32 m0, 79872
    s_nop 0
    buffer_load_dwordx4 v26, s[28:31], s13 offen lds
    s_mov_b32 m0, 80896
    s_nop 0
    buffer_load_dwordx4 v27, s[28:31], s13 offen lds
    s_mov_b32 m0, 81920
    s_nop 0
    buffer_load_dwordx4 v28, s[28:31], s13 offen lds
    s_add_u32 s13, s12, 294912
    s_mov_b32 m0, 82944
    s_nop 0
    buffer_load_dwordx4 v20, s[28:31], s13 offen lds
    s_mov_b32 m0, 83968
    s_nop 0
    buffer_load_dwordx4 v21, s[28:31], s13 offen lds
    s_mov_b32 m0, 84992
    s_nop 0
    buffer_load_dwordx4 v22, s[28:31], s13 offen lds
    s_mov_b32 m0, 86016
    s_nop 0
    buffer_load_dwordx4 v23, s[28:31], s13 offen lds
    s_mov_b32 m0, 87040
    s_nop 0
    buffer_load_dwordx4 v24, s[28:31], s13 offen lds
    s_mov_b32 m0, 88064
    s_nop 0
    buffer_load_dwordx4 v25, s[28:31], s13 offen lds
    s_mov_b32 m0, 89088
    s_nop 0
    buffer_load_dwordx4 v26, s[28:31], s13 offen lds
    s_mov_b32 m0, 90112
    s_nop 0
    buffer_load_dwordx4 v27, s[28:31], s13 offen lds
    s_mov_b32 m0, 91136
    s_nop 0
    buffer_load_dwordx4 v28, s[28:31], s13 offen lds
    s_add_u32 s13, s12, 368640
    s_mov_b32 m0, 92160
    s_nop 0
    buffer_load_dwordx4 v20, s[28:31], s13 offen lds
    s_mov_b32 m0, 93184
    s_nop 0
    buffer_load_dwordx4 v21, s[28:31], s13 offen lds
    s_mov_b32 m0, 94208
    s_nop 0
    buffer_load_dwordx4 v22, s[28:31], s13 offen lds
    s_mov_b32 m0, 95232
    s_nop 0
    buffer_load_dwordx4 v23, s[28:31], s13 offen lds
    s_mov_b32 m0, 96256
    s_nop 0
    buffer_load_dwordx4 v24, s[28:31], s13 offen lds
    s_mov_b32 m0, 97280
    s_nop 0
    buffer_load_dwordx4 v25, s[28:31], s13 offen lds
    s_mov_b32 m0, 98304
    s_nop 0
    buffer_load_dwordx4 v26, s[28:31], s13 offen lds
    s_mov_b32 m0, 99328
    s_nop 0
    buffer_load_dwordx4 v27, s[28:31], s13 offen lds
    s_mov_b32 m0, 100352
    s_nop 0
    buffer_load_dwordx4 v28, s[28:31], s13 offen lds
    s_waitcnt vmcnt(54)
    s_add_u32 s13, s12, 442368
    s_mov_b32 m0, 129024
    s_nop 0
    buffer_load_dwordx4 v20, s[28:31], s13 offen lds
    s_mov_b32 m0, 130048
    s_nop 0
    buffer_load_dwordx4 v21, s[28:31], s13 offen lds
    s_mov_b32 m0, 131072
    s_nop 0
    buffer_load_dwordx4 v22, s[28:31], s13 offen lds
    s_mov_b32 m0, 132096
    s_nop 0
    buffer_load_dwordx4 v23, s[28:31], s13 offen lds
    s_mov_b32 m0, 133120
    s_nop 0
    buffer_load_dwordx4 v24, s[28:31], s13 offen lds
    s_mov_b32 m0, 134144
    s_nop 0
    buffer_load_dwordx4 v25, s[28:31], s13 offen lds
    s_mov_b32 m0, 135168
    s_nop 0
    buffer_load_dwordx4 v26, s[28:31], s13 offen lds
    s_mov_b32 m0, 136192
    s_nop 0
    buffer_load_dwordx4 v27, s[28:31], s13 offen lds
    s_mov_b32 m0, 137216
    s_nop 0
    buffer_load_dwordx4 v28, s[28:31], s13 offen lds
    s_waitcnt vmcnt(54)
    s_add_u32 s13, s12, 516096
    s_mov_b32 m0, 138240
    s_nop 0
    buffer_load_dwordx4 v20, s[28:31], s13 offen lds
    s_mov_b32 m0, 139264
    s_nop 0
    buffer_load_dwordx4 v21, s[28:31], s13 offen lds
    s_mov_b32 m0, 140288
    s_nop 0
    buffer_load_dwordx4 v22, s[28:31], s13 offen lds
    s_mov_b32 m0, 141312
    s_nop 0
    buffer_load_dwordx4 v23, s[28:31], s13 offen lds
    s_mov_b32 m0, 142336
    s_nop 0
    buffer_load_dwordx4 v24, s[28:31], s13 offen lds
    s_mov_b32 m0, 143360
    s_nop 0
    buffer_load_dwordx4 v25, s[28:31], s13 offen lds
    s_mov_b32 m0, 144384
    s_nop 0
    buffer_load_dwordx4 v26, s[28:31], s13 offen lds
    s_mov_b32 m0, 145408
    s_nop 0
    buffer_load_dwordx4 v27, s[28:31], s13 offen lds
    s_mov_b32 m0, 146432
    s_nop 0
    buffer_load_dwordx4 v28, s[28:31], s13 offen lds
    s_waitcnt vmcnt(54)
    s_add_u32 s13, s12, 589824
    s_mov_b32 m0, 147456
    s_nop 0
    buffer_load_dwordx4 v20, s[28:31], s13 offen lds
    s_mov_b32 m0, 148480
    s_nop 0
    buffer_load_dwordx4 v21, s[28:31], s13 offen lds
    s_mov_b32 m0, 149504
    s_nop 0
    buffer_load_dwordx4 v22, s[28:31], s13 offen lds
    s_mov_b32 m0, 150528
    s_nop 0
    buffer_load_dwordx4 v23, s[28:31], s13 offen lds
    s_mov_b32 m0, 151552
    s_nop 0
    buffer_load_dwordx4 v24, s[28:31], s13 offen lds
    s_mov_b32 m0, 152576
    s_nop 0
    buffer_load_dwordx4 v25, s[28:31], s13 offen lds
    s_mov_b32 m0, 153600
    s_nop 0
    buffer_load_dwordx4 v26, s[28:31], s13 offen lds
    s_mov_b32 m0, 154624
    s_nop 0
    buffer_load_dwordx4 v27, s[28:31], s13 offen lds
    s_mov_b32 m0, 155648
    s_nop 0
    buffer_load_dwordx4 v28, s[28:31], s13 offen lds
    ds_write_b32 v2, v3 offset:112
    s_waitcnt vmcnt(54)
    ds_write_b32 v2, v3 offset:20
    s_cmp_lg_u32 s9, 0
    s_cbranch_scc1 NT_98
NL_99:
    v_readfirstlane_b32 s9, v17
    s_cmp_lg_u32 s9, 0
    s_cbranch_scc1 NG_100
    buffer_load_dword v17, v18, s[68:71], 0 offen sc1
    s_branch NT_98
NG_100:
    v_or_b32 v17, 1, v17
    s_or_b32 s9, s9, 1
    ds_write_b32 v2, v17 offset:44
NT_98:
    s_waitcnt vmcnt(27)
L_l_wq2:
    s_waitcnt vmcnt(27)
    ds_write_b32 v2, v6 offset:20
    v_add_u32 v5, 0, v1
    v_mul_u32_u24 v8, 7282, v5
    v_lshrrev_b32 v8, 16, v8
    v_mul_u32_u24 v9, 9, v8
    v_sub_u32 v9, v5, v9
    v_lshrrev_b32 v10, 4, v8
    v_lshl_add_u32 v10, v10, 1, v8
    v_mul_u32_u24 v10, 1152, v10
    v_lshl_add_u32 v32, v9, 4, v10
    v_add_u32 v5, 64, v1
    v_mul_u32_u24 v8, 7282, v5
    v_lshrrev_b32 v8, 16, v8
    v_mul_u32_u24 v9, 9, v8
    v_sub_u32 v9, v5, v9
    v_lshrrev_b32 v10, 4, v8
    v_lshl_add_u32 v10, v10, 1, v8
    v_mul_u32_u24 v10, 1152, v10
    v_lshl_add_u32 v33, v9, 4, v10
    v_add_u32 v5, 128, v1
    v_mul_u32_u24 v8, 7282, v5
    v_lshrrev_b32 v8, 16, v8
    v_mul_u32_u24 v9, 9, v8
    v_sub_u32 v9, v5, v9
    v_lshrrev_b32 v10, 4, v8
    v_lshl_add_u32 v10, v10, 1, v8
    v_mul_u32_u24 v10, 1152, v10
    v_lshl_add_u32 v34, v9, 4, v10
    v_add_u32 v5, 192, v1
    v_mul_u32_u24 v8, 7282, v5
    v_lshrrev_b32 v8, 16, v8
    v_mul_u32_u24 v9, 9, v8
    v_sub_u32 v9, v5, v9
    v_lshrrev_b32 v10, 4, v8
    v_lshl_add_u32 v10, v10, 1, v8
    v_mul_u32_u24 v10, 1152, v10
    v_lshl_add_u32 v35, v9, 4, v10
    v_add_u32 v5, 256, v1
    v_mul_u32_u24 v8, 7282, v5
    v_lshrrev_b32 v8, 16, v8
    v_mul_u32_u24 v9, 9, v8
    v_sub_u32 v9, v5, v9
    v_lshrrev_b32 v10, 4, v8
    v_lshl_add_u32 v10, v10, 1, v8
    v_mul_u32_u24 v10, 1152, v10
    v_lshl_add_u32 v36, v9, 4, v10
    v_add_u32 v5, 320, v1
    v_mul_u32_u24 v8, 7282, v5
    v_lshrrev_b32 v8, 16, v8
    v_mul_u32_u24 v9, 9, v8
    v_sub_u32 v9, v5, v9
    v_lshrrev_b32 v10, 4, v8
    v_lshl_add_u32 v10, v10, 1, v8
    v_mul_u32_u24 v10, 1152, v10
    v_lshl_add_u32 v37, v9, 4, v10
    v_add_u32 v5, 384, v1
    v_mul_u32_u24 v8, 7282, v5
    v_lshrrev_b32 v8, 16, v8
    v_mul_u32_u24 v9, 9, v8
    v_sub_u32 v9, v5, v9
    v_lshrrev_b32 v10, 4, v8
    v_lshl_add_u32 v10, v10, 1, v8
    v_mul_u32_u24 v10, 1152, v10
    v_lshl_add_u32 v38, v9, 4, v10
    v_add_u32 v5, 448, v1
    v_mul_u32_u24 v8, 7282, v5
    v_lshrrev_b32 v8, 16, v8
    v_mul_u32_u24 v9, 9, v8
    v_sub_u32 v9, v5, v9
    v_lshrrev_b32 v10, 4, v8
    v_lshl_add_u32 v10, v10, 1, v8
    v_mul_u32_u24 v10, 1152, v10
    v_lshl_add_u32 v39, v9, 4, v10
    v_add_u32 v5, 512, v1
    v_mul_u32_u24 v8, 7282, v5
    v_lshrrev_b32 v8, 16, v8
    v_mul_u32_u24 v9, 9, v8
    v_sub_u32 v9, v5, v9
    v_lshrrev_b32 v10, 4, v8
    v_lshl_add_u32 v10, v10, 1, v8
    v_mul_u32_u24 v10, 1152, v10
    v_lshl_add_u32 v40, v9, 4, v10
    v_add_u32 v5, 576, v1
    v_mul_u32_u24 v8, 7282, v5
    v_lshrrev_b32 v8, 16, v8
    v_mul_u32_u24 v9, 9, v8
    v_sub_u32 v9, v5, v9
    v_lshrrev_b32 v10, 4, v8
    v_lshl_add_u32 v10, v10, 1, v8
    v_subrev_u32 v5, 64, v8
    v_mul_u32_u24 v10, 9, v5
    v_and_b32 v5, 1, v5
    v_lshlrev_b32 v5, 3, v5
    v_sub_u32 v10, v10, v5
    v_add_u32 v10, 16, v10
    v_mul_u32_u24 v10, 1152, v10
    v_lshl_add_u32 v41, v9, 4, v10
    v_add_u32 v5, 640, v1
    v_mul_u32_u24 v8, 7282, v5
    v_lshrrev_b32 v8, 16, v8
    v_mul_u32_u24 v9, 9, v8
    v_sub_u32 v9, v5, v9
    v_lshrrev_b32 v10, 4, v8
    v_lshl_add_u32 v10, v10, 1, v8
    v_subrev_u32 v5, 64, v8
    v_mul_u32_u24 v10, 9, v5
    v_and_b32 v5, 1, v5
    v_lshlrev_b32 v5, 3, v5
    v_sub_u32 v10, v10, v5
    v_add_u32 v10, 16, v10
    v_mul_u32_u24 v10, 1152, v10
    v_lshl_add_u32 v42, v9, 4, v10
    v_and_b32 v5, 15, v1
    v_lshlrev_b32 v5, 7, v5
    v_add_u32 v5, 7340032, v5
    v_mov_b32 v14, 0
    v_lshlrev_b32 v15, 4, v1
    v_and_b32 v16, 7, v1
    v_lshlrev_b32 v16, 2, v16
    v_add_u32 v16, 163712, v16
    s_mov_b32 s73, 0
    s_mov_b32 s74, 103424
    s_mov_b32 s75, 16
    s_mov_b32 s16, 0
    s_waitcnt vmcnt(0)
    ds_write_b32 v2, v7 offset:20
    s_cmp_lg_u32 s9, 0
    s_cbranch_scc1 NT_101
NL_102:
    v_readfirstlane_b32 s9, v17
    s_cmp_lg_u32 s9, 0
    s_cbranch_scc1 NG_103
    s_sub_u32 s8, s8, 16
    s_cselect_b32 s8, 0, s8
    s_cbranch_scc1 NG_103
    buffer_load_dword v17, v18, s[68:71], 0 offen sc1
    s_waitcnt vmcnt(0)
    s_branch NL_102
NG_103:
    v_or_b32 v17, 1, v17
    s_or_b32 s9, s9, 1
    ds_write_b32 v2, v17 offset:44
NT_101:
    s_mov_b32 s76, 0
    s_and_b32 s13, s2, 7
    s_lshl_b32 s10, s13, 11
    v_add_u32 v7, s10, v5
    v_lshlrev_b32 v54, 7, v1
    v_add_u32 v54, 7340032, v54
    v_add_u32 v55, 8192, v54
    buffer_load_dword v56, v7, s[20:23], 0 offen sc1
P_104:
    s_sleep 1
    buffer_load_dword v57, v7, s[20:23], 0 offen sc1
    s_waitcnt vmcnt(1)
    v_cmp_ne_u32 vcc, s9, v56
    s_cbranch_vccz PD_105
    s_sleep 1
    buffer_load_dword v56, v7, s[20:23], 0 offen sc1
    s_waitcnt vmcnt(1)
    v_cmp_ne_u32 vcc, s9, v57
    s_cbranch_vccz PD_105
    s_sub_u32 s8, s8, 16
    s_cselect_b32 s8, 0, s8
    s_cbranch_scc1 PD_105
    s_branch P_104
PD_105:
W_106:
    ds_read_b32 v4, v2 offset:28
    s_waitcnt lgkmcnt(0)
    v_readfirstlane_b32 s3, v4
    s_cmp_ge_u32 s3, 8
    s_cbranch_scc1 WD_107
    s_sub_u32 s8, s8, 1
    s_cselect_b32 s8, 0, s8
    s_cbranch_scc1 WD_107
    s_sleep 0
    s_branch W_106
WD_107:
    s_mov_b32 s15, 0
    s_mul_i32 s10, s13, 20480
    s_mul_i32 s11, s15, 10240
    s_add_u32 s10, s10, s11
    s_add_u32 s11, s11, s74
    s_add_u32 m0, s11, 0
    s_nop 0
    buffer_load_dwordx4 v15, s[20:23], s10 offen sc1 lds
    buffer_load_dwordx4 v15, s[20:23], s10 offen offset:1024 sc1 lds
    buffer_load_dwordx4 v15, s[20:23], s10 offen offset:2048 sc1 lds
    buffer_load_dwordx4 v15, s[20:23], s10 offen offset:3072 sc1 lds
    s_add_u32 s10, s10, 4096
    s_add_u32 m0, s11, 4096
    s_nop 0
    buffer_load_dwordx4 v15, s[20:23], s10 offen sc1 lds
    buffer_load_dwordx4 v15, s[20:23], s10 offen offset:1024 sc1 lds
    buffer_load_dwordx4 v15, s[20:23], s10 offen offset:2048 sc1 lds
    buffer_load_dwordx4 v15, s[20:23], s10 offen offset:3072 sc1 lds
    s_add_u32 s10, s10, 4096
    s_add_u32 m0, s11, 8192
    s_nop 0
    buffer_load_dwordx4 v15, s[20:23], s10 offen sc1 lds
    buffer_load_dwordx4 v15, s[20:23], s10 offen offset:1024 sc1 lds
    s_mov_b32 s15, 1
    s_mul_i32 s10, s13, 20480
    s_mul_i32 s11, s15, 10240
    s_add_u32 s10, s10, s11
    s_add_u32 s11, s11, s74
    s_add_u32 m0, s11, 0
    s_nop 0
    buffer_load_dwordx4 v15, s[20:23], s10 offen sc1 lds
    buffer_load_dwordx4 v15, s[20:23], s10 offen offset:1024 sc1 lds
    buffer_load_dwordx4 v15, s[20:23], s10 offen offset:2048 sc1 lds
    buffer_load_dwordx4 v15, s[20:23], s10 offen offset:3072 sc1 lds
    s_add_u32 s10, s10, 4096
    s_add_u32 m0, s11, 4096
    s_nop 0
    buffer_load_dwordx4 v15, s[20:23], s10 offen sc1 lds
    buffer_load_dwordx4 v15, s[20:23], s10 offen offset:1024 sc1 lds
    buffer_load_dwordx4 v15, s[20:23], s10 offen offset:2048 sc1 lds
    buffer_load_dwordx4 v15, s[20:23], s10 offen offset:3072 sc1 lds
    s_add_u32 s10, s10, 4096
    s_add_u32 m0, s11, 8192
    s_nop 0
    buffer_load_dwordx4 v15, s[20:23], s10 offen sc1 lds
    buffer_load_dwordx4 v15, s[20:23], s10 offen offset:1024 sc1 lds
    buffer_load_dwordx2 v[12:13], v54, s[20:23], 0 offen sc1
    buffer_load_dwordx2 v[52:53], v55, s[20:23], 0 offen sc1
    v_mov_b32 v6, 1
    v_mov_b32 v7, 2
    s_waitcnt vmcnt(12)
    ds_write_b32 v2, v6 offset:40
    s_waitcnt vmcnt(2)
    ds_write_b32 v2, v7 offset:40
    s_mov_b32 s73, 2
    s_mov_b32 s76, 2
    s_mov_b32 s74, 82944
    s_waitcnt vmcnt(0)
    v_cmp_ne_u32 s[64:65], s9, v12
    v_cmp_ne_u32 s[66:67], s9, v52
    v_max_f32 v14, v13, v53
L_ld:
    s_cmp_ge_u32 s73, s75
    s_cbranch_scc1 L_ld_wait
    s_sub_u32 s10, s73, s76
    s_cmp_ge_u32 s10, 2
    s_cbranch_scc1 L_ld_wait
    s_lshr_b32 s14, s73, 1
    s_add_u32 s13, s14, s2
    s_and_b32 s13, s13, 7
    s_and_b32 s15, s73, 1
L_ld_fl:
    s_bitcmp1_b32 s13, 2
    s_cselect_b64 s[16:17], s[66:67], s[64:65]
    s_and_b32 s10, s13, 3
    s_lshl_b32 s10, s10, 4
    s_lshr_b64 s[16:17], s[16:17], s10
    s_and_b32 s16, s16, 0xffff
    s_cbranch_scc0 L_ld_flok
    s_sub_u32 s8, s8, 16
    s_cselect_b32 s8, 0, s8
    s_cbranch_scc1 L_ld_flok
    buffer_load_dwordx2 v[12:13], v54, s[20:23], 0 offen sc1
    buffer_load_dwordx2 v[52:53], v55, s[20:23], 0 offen sc1
    s_waitcnt vmcnt(0)
    s_mov_b32 s76, s73
    v_mov_b32 v6, s73
    ds_write_b32 v2, v6 offset:40
    v_cmp_ne_u32 s[64:65], s9, v12
    v_cmp_ne_u32 s[66:67], s9, v52
    v_max_f32 v14, v13, v53
    s_nop 0
    s_branch L_ld_fl
L_ld_flok:
    s_cmp_ge_u32 s73, 6
    s_cbranch_scc1 L_ld_prog
L_ld_nopoll:
    s_lshl_b32 s10, s14, 2
    v_add_u32 v6, s10, v2
    ds_read_b32 v4, v6 offset:28
    s_waitcnt lgkmcnt(0)
    v_cmp_gt_u32 vcc, 8, v4
    s_branch L_ld_test
L_ld_prog:
    s_sub_u32 s10, s73, 5
    ds_read_b32 v4, v16
    s_waitcnt lgkmcnt(0)
    v_cmp_gt_u32 vcc, s10, v4
L_ld_test:
    s_cbranch_vccz L_ld_go
    s_cmp_lg_u32 s73, s76
    s_cbranch_scc1 L_ld_wait
    s_sub_u32 s8, s8, 1
    s_cselect_b32 s8, 0, s8
    s_cbranch_scc1 L_ld_go
    s_sleep 4
    s_branch L_ld
L_ld_go:
    s_mul_i32 s10, s13, 20480
    s_mul_i32 s11, s15, 10240
    s_add_u32 s10, s10, s11
    s_add_u32 s11, s11, s74
    s_add_u32 m0, s11, 0
    s_nop 0
    buffer_load_dwordx4 v15, s[20:23], s10 offen sc1 lds
    buffer_load_dwordx4 v15, s[20:23], s10 offen offset:1024 sc1 lds
    buffer_load_dwordx4 v15, s[20:23], s10 offen offset:2048 sc1 lds
    buffer_load_dwordx4 v15, s[20:23], s10 offen offset:3072 sc1 lds
    s_add_u32 s10, s10, 4096
    s_add_u32 m0, s11, 4096
    s_nop 0
    buffer_load_dwordx4 v15, s[20:23], s10 offen sc1 lds
    buffer_load_dwordx4 v15, s[20:23], s10 offen offset:1024 sc1 lds
    buffer_load_dwordx4 v15, s[20:23], s10 offen offset:2048 sc1 lds
    buffer_load_dwordx4 v15, s[20:23], s10 offen offset:3072 sc1 lds
    s_add_u32 s10, s10, 4096
    s_add_u32 m0, s11, 8192
    s_nop 0
    buffer_load_dwordx4 v15, s[20:23], s10 offen sc1 lds
    buffer_load_dwordx4 v15, s[20:23], s10 offen offset:1024 sc1 lds
    s_cmp_lg_u32 s73, 15
    s_cbranch_scc1 L_ld_nochk
    ds_read_b32 v6, v2 offset:48
    v_and_b32 v7, 2, v1
    v_cmp_eq_u32 vcc, 0, v7
    s_waitcnt lgkmcnt(0)
    v_mul_f32 v6, v6, v14
    v_mov_b32 v7, 0x5d800000
    v_mov_b32 v8, 0x44bb8000
    v_cndmask_b32 v6, v14, v6, vcc
    v_cndmask_b32 v7, v7, v8, vcc
    s_nop 0
    v_cmp_nle_f32 vcc, v6, v7
    s_cbranch_vccz L_ld_nochk
    s_mov_b32 s75, 48
    ds_write_b32 v2, v3 offset:80
L_ld_nochk:
    s_cmp_lg_u32 s73, 10
    s_cbranch_scc1 L_ld_nowo
    s_lshr_b32 s10, s2, 3
    s_mul_i32 s10, s10, 20736
    v_lshlrev_b32 v7, 7, v1
    v_add_u32 v8, 8192, v7
    v_add_u32 v9, 16384, v7
    v_min_u32 v9, 20608, v9
    buffer_load_dword v44, v7, s[24:27], s10 offen
    buffer_load_dword v45, v8, s[24:27], s10 offen
    buffer_load_dword v46, v9, s[24:27], s10 offen
L_ld_nowo:
    s_add_u32 s73, s73, 1
    s_cmp_eq_u32 s15, 0
    s_cbranch_scc1 L_ld
    s_sub_u32 s74, s74, 20480
    s_cmp_lt_u32 s74, 82944
    s_cselect_b32 s74, 123904, s74
    s_branch L_ld
L_ld_wait:
    s_add_u32 s76, s76, 1
    v_mov_b32 v6, s76
    s_cmp_eq_u32 s76, s73
    s_cbranch_scc1 L_ld_w0
    s_waitcnt vmcnt(10) lgkmcnt(0)
    s_branch L_ld_w1
L_ld_w0:
    s_waitcnt vmcnt(0) lgkmcnt(0)
L_ld_w1:
    ds_write_b32 v2, v6 offset:40
    s_cmp_lt_u32 s76, s75
    s_cbranch_scc1 L_ld
W_108:
    ds_read_b32 v4, v2 offset:72
    s_waitcnt lgkmcnt(0)
    v_readfirstlane_b32 s3, v4
    s_cmp_ge_u32 s3, 1
    s_cbranch_scc1 WD_109
    s_sub_u32 s8, s8, 1
    s_cselect_b32 s8, 0, s8
    s_cbranch_scc1 WD_109
    s_sleep 4
    s_branch W_108
WD_109:
    ds_read_b32 v4, v16
    s_sub_u32 s10, s75, 2
    s_waitcnt lgkmcnt(0)
    v_cmp_gt_u32 vcc, s10, v4
    s_cbranch_vccnz L_wo_go
W_110:
    ds_read_b32 v4, v2 offset:100
    s_waitcnt lgkmcnt(0)
    v_readfirstlane_b32 s3, v4
    s_cmp_ge_u32 s3, 2
    s_cbranch_scc1 WD_111
    s_sub_u32 s8, s8, 1
    s_cselect_b32 s8, 0, s8
    s_cbranch_scc1 WD_111
    s_sleep 1
    s_branch W_110
WD_111:
L_wo_go:
    s_mov_b32 s11, 0
    s_mov_b32 s13, 8
L_wo:
    s_add_u32 m0, s11, 0
    s_nop 0
    buffer_load_dwordx4 v32, s[24:27], s12 offen lds
    s_add_u32 m0, s11, 1024
    s_nop 0
    buffer_load_dwordx4 v33, s[24:27], s12 offen lds
    s_add_u32 m0, s11, 2048
    s_nop 0
    buffer_load_dwordx4 v34, s[24:27], s12 offen lds
    s_add_u32 m0, s11, 3072
    s_nop 0
    buffer_load_dwordx4 v35, s[24:27], s12 offen lds
    s_add_u32 m0, s11, 4096
    s_nop 0
    buffer_load_dwordx4 v36, s[24:27], s12 offen lds
    s_add_u32 m0, s11, 5120
    s_nop 0
    buffer_load_dwordx4 v37, s[24:27], s12 offen lds
    s_add_u32 m0, s11, 6144
    s_nop 0
    buffer_load_dwordx4 v38, s[24:27], s12 offen lds
    s_add_u32 m0, s11, 7168
    s_nop 0
    buffer_load_dwordx4 v39, s[24:27], s12 offen lds
    s_add_u32 m0, s11, 8192
    s_nop 0
    buffer_load_dwordx4 v40, s[24:27], s12 offen lds
    s_add_u32 m0, s11, 9216
    s_nop 0
    buffer_load_dwordx4 v41, s[24:27], s12 offen lds
    s_mov_b64 exec, 0xff
    s_add_u32 m0, s11, 10240
    s_nop 0
    buffer_load_dwordx4 v42, s[24:27], s12 offen lds
    s_mov_b64 exec, -1
    s_add_u32 s12, s12, 82944
    s_add_u32 s11, s11, 10368
    s_waitcnt vmcnt(44)
    s_sub_u32 s13, s13, 1
    s_cmp_lg_u32 s13, 0
    s_cbranch_scc1 L_wo
    s_waitcnt vmcnt(0)
    ds_write_b32 v2, v3 offset:84
    s_waitcnt lgkmcnt(0)
    s_endpgm
L_a_rest:
    v_and_b32 v104, 31, v1
    s_lshl_b32 s10, s73, 5
    v_add_u32 v104, s10, v104
    v_lshrrev_b32 v107, 5, v1
    v_mul_u32_u24 v105, 144, v104
    v_add_u32 v105, 153600, v105
    s_lshl_b32 s11, s72, 5
    v_lshl_add_u32 v12, v107, 4, v105
    v_add_u32 v12, s11, v12
    s_lshl_b32 s11, s72, 2
    s_add_u32 s11, s11, 128
    v_add_u32 v13, s11, v105
    s_mul_i32 s11, s73, 4608
    s_add_u32 s11, s11, 153600
    v_lshlrev_b32 v14, 4, v1
    v_add_u32 v15, s11, v14
    v_lshrrev_b32 v105, 3, v104
    v_mul_u32_u24 v105, 9216, v105
    v_and_b32 v106, 7, v104
    v_lshl_add_u32 v105, v106, 7, v105
    v_bfe_u32 v106, v104, 1, 3
    v_xor_b32 v106, v106, v107
    v_lshl_add_u32 v6, v106, 4, v105
    v_xor_b32 v104, 2, v106
    v_lshl_add_u32 v7, v104, 4, v105
    v_xor_b32 v104, 4, v106
    v_lshl_add_u32 v8, v104, 4, v105
    v_xor_b32 v104, 6, v106
    v_lshl_add_u32 v9, v104, 4, v105
    s_bitcmp1_b32 s72, 0
    s_mov_b32 s10, 0x44443120
    s_cselect_b32 s10, 0x44423120, s10
    s_mul_i32 s11, s72, 9
    s_lshr_b32 s11, s11, 1
    v_bfe_u32 v104, v1, 4, 1
    v_and_b32 v105, 3, v1
    v_lshl_add_u32 v104, v104, 2, v105
    v_lshlrev_b32 v104, 2, v104
    v_lshrrev_b32 v104, v104, s10
    v_and_b32 v104, 15, v104
    v_add_u32 v104, s11, v104
    v_lshrrev_b32 v105, 5, v1
    v_bfe_u32 v106, v1, 2, 2
    v_lshl_add_u32 v105, v105, 3, v106
    v_mul_u32_u24 v105, 144, v105
    v_max_u32 v106, 1, v106
    v_lshl_add_u32 v104, v106, 1, v104
    v_subrev_u32 v104, 2, v104
    v_subrev_u32 v106, 18, v104
    v_min_u32 v104, v104, v106
    v_lshl_add_u32 v10, v104, 3, v105
    v_add_u32 v11, 129024, v10
    v_add_u32 v10, 73728, v10
    v_lshlrev_b32 v96, 4, v1
    v_add_u32 v96, 103424, v96
    v_and_b32 v104, 31, v1
    v_lshlrev_b32 v97, 4, v104
    v_add_u32 v97, 103424, v97
    v_min_u32 v105, 19, v104
    v_cmp_eq_u32 vcc, 28, v104
    s_nop 1
    v_cndmask_b32 v105, v105, 18, vcc
    v_lshrrev_b32 v106, 5, v1
    v_mul_u32_u24 v106, 20, v106
    v_add_u32 v105, v105, v106
    v_lshlrev_b32 v98, 4, v105
    v_add_u32 v98, 105472, v98
    s_lshl_b32 s10, s4, 2
    s_add_u32 s10, s10, 163712
    v_mov_b32 v100, s10
    v_mov_b32 v48, 0
    v_mov_b32 v49, 0
    v_mov_b32 v50, 0
    v_mov_b32 v51, 0
    v_mov_b32 v52, 0
    v_mov_b32 v53, 0
    v_mov_b32 v54, 0
    v_mov_b32 v55, 0
    v_mov_b32 v56, 0
    v_mov_b32 v57, 0
    v_mov_b32 v58, 0
    v_mov_b32 v59, 0
    v_mov_b32 v60, 0
    v_mov_b32 v61, 0
    v_mov_b32 v62, 0
    v_mov_b32 v63, 0
    s_mov_b32 s32, s58
    s_mov_b32 s33, s59
    s_mov_b32 s34, 4718592
    s_mov_b32 s35, 0x20000
    s_cmp_lt_u32 s7, 4
    s_cbranch_scc0 L_a_x3
    s_cmp_lg_u32 s15, 0
    s_cbranch_scc1 L_a_x2
    s_branch L_a_x3
L_a_x2:
W_1:
    ds_read_b32 v4, v2 offset:8
    s_waitcnt lgkmcnt(0)
    v_readfirstlane_b32 s3, v4
    s_cmp_ge_u32 s3, 4
    s_cbranch_scc1 WD_2
    s_sub_u32 s8, s8, 1
    s_cselect_b32 s8, 0, s8
    s_cbranch_scc1 WD_2
    s_sleep 1
    s_branch W_1
WD_2:
    s_add_u32 m0, s12, 0
    s_nop 0
    buffer_load_dwordx4 v5, s[24:27], 0 offen lds
    s_add_u32 m0, s12, 896
    s_nop 0
    buffer_load_dwordx4 v5, s[24:27], 0 offen offset:128 lds
    s_add_u32 m0, s12, 1792
    s_nop 0
    buffer_load_dwordx4 v5, s[24:27], 0 offen offset:256 lds
    s_add_u32 m0, s12, 2688
    s_nop 0
    buffer_load_dwordx4 v5, s[24:27], 0 offen offset:384 lds
    s_add_u32 m0, s12, 3584
    s_nop 0
    buffer_load_dwordx4 v5, s[24:27], 0 offen offset:512 lds
    s_add_u32 m0, s12, 4480
    s_nop 0
    buffer_load_dwordx4 v5, s[24:27], 0 offen offset:640 lds
    s_add_u32 m0, s12, 5376
    s_nop 0
    buffer_load_dwordx4 v5, s[24:27], 0 offen offset:768 lds
    s_add_u32 m0, s12, 6272
    s_nop 0
    buffer_load_dwordx4 v5, s[24:27], 0 offen offset:896 lds
    s_add_u32 m0, s12, 7168
    s_nop 0
    buffer_load_dwordx4 v5, s[24:27], 0 offen offset:1024 lds
L_a_x3:
    s_waitcnt vmcnt(0)
    s_mov_b64 exec, 1
    ds_add_u32 v2, v3 offset:12
    s_mov_b64 exec, -1
W_3:
    ds_read_b32 v4, v2 offset:12
    s_waitcnt lgkmcnt(0)
    v_readfirstlane_b32 s3, v4
    s_cmp_ge_u32 s3, 8
    s_cbranch_scc1 WD_4
    s_sub_u32 s8, s8, 1
    s_cselect_b32 s8, 0, s8
    s_cbranch_scc1 WD_4
    s_sleep 1
    s_branch W_3
WD_4:
W_5:
    ds_read_b32 v4, v2 offset:20
    s_waitcnt lgkmcnt(0)
    v_readfirstlane_b32 s3, v4
    s_cmp_ge_u32 s3, 1
    s_cbranch_scc1 WD_6
    s_sub_u32 s8, s8, 1
    s_cselect_b32 s8, 0, s8
    s_cbranch_scc1 WD_6
    s_sleep 1
    s_branch W_5
WD_6:
    ds_read_b64_tr_b16 v[16:17], v10 offset:27648
    ds_read_b64_tr_b16 v[18:19], v10 offset:28224
    ds_read_b128 v[20:23], v6 offset:0
    ds_read_b64_tr_b16 v[24:25], v10 offset:29952
    ds_read_b64_tr_b16 v[26:27], v10 offset:30528
    ds_read_b128 v[28:31], v7 offset:0
    ds_read_b64_tr_b16 v[32:33], v10 offset:32256
    ds_read_b64_tr_b16 v[34:35], v10 offset:32832
    ds_read_b128 v[36:39], v8 offset:0
    ds_read_b64_tr_b16 v[40:41], v10 offset:34560
    ds_read_b64_tr_b16 v[42:43], v10 offset:35136
    ds_read_b128 v[44:47], v9 offset:0
    s_waitcnt lgkmcnt(9)
    v_mfma_f32_32x32x16_bf16 v[48:63], v[16:19], v[20:23], v[48:63]
    ds_read_b64_tr_b16 v[16:17], v10 offset:36864
    ds_read_b64_tr_b16 v[18:19], v10 offset:37440
    ds_read_b128 v[20:23], v6 offset:1024
    s_waitcnt lgkmcnt(9)
    v_mfma_f32_32x32x16_bf16 v[48:63], v[24:27], v[28:31], v[48:63]
    ds_read_b64_tr_b16 v[24:25], v10 offset:39168
    ds_read_b64_tr_b16 v[26:27], v10 offset:39744
    ds_read_b128 v[28:31], v7 offset:1024
    s_waitcnt lgkmcnt(9)
    v_mfma_f32_32x32x16_bf16 v[48:63], v[32:35], v[36:39], v[48:63]
    ds_read_b64_tr_b16 v[32:33], v10 offset:41472
    ds_read_b64_tr_b16 v[34:35], v10 offset:42048
    ds_read_b128 v[36:39], v8 offset:1024
    s_waitcnt lgkmcnt(9)
    v_mfma_f32_32x32x16_bf16 v[48:63], v[40:43], v[44:47], v[48:63]
    ds_read_b64_tr_b16 v[40:41], v10 offset:43776
    ds_read_b64_tr_b16 v[42:43], v10 offset:44352
    ds_read_b128 v[44:47], v9 offset:1024
    s_waitcnt lgkmcnt(9)
    v_mfma_f32_32x32x16_bf16 v[48:63], v[16:19], v[20:23], v[48:63]
    ds_read_b64_tr_b16 v[16:17], v10 offset:46080
    ds_read_b64_tr_b16 v[18:19], v10 offset:46656
    ds_read_b128 v[20:23], v6 offset:2048
    s_waitcnt lgkmcnt(9)
    v_mfma_f32_32x32x16_bf16 v[48:63], v[24:27], v[28:31], v[48:63]
    ds_read_b32 v99, v2 offset:20
    ds_read_b64_tr_b16 v[24:25], v10 offset:48384
    ds_read_b64_tr_b16 v[26:27], v10 offset:48960
    ds_read_b128 v[28:31], v7 offset:2048
    s_waitcnt lgkmcnt(10)
    v_mfma_f32_32x32x16_bf16 v[48:63], v[32:35], v[36:39], v[48:63]
    ds_read_b64_tr_b16 v[32:33], v10 offset:50688
    ds_read_b64_tr_b16 v[34:35], v10 offset:51264
    ds_read_b128 v[36:39], v8 offset:2048
    s_waitcnt lgkmcnt(10)
    v_mfma_f32_32x32x16_bf16 v[48:63], v[40:43], v[44:47], v[48:63]
    ds_read_b64_tr_b16 v[40:41], v10 offset:52992
    ds_read_b64_tr_b16 v[42:43], v10 offset:53568
    ds_read_b128 v[44:47], v9 offset:2048
    s_waitcnt lgkmcnt(10)
    v_mfma_f32_32x32x16_bf16 v[48:63], v[16:19], v[20:23], v[48:63]
    s_waitcnt lgkmcnt(9)
    v_readfirstlane_b32 s3, v99
    s_cmp_lt_u32 s3, 2
    s_cbranch_scc1 QS_7
QB_8:
    ds_read_b64_tr_b16 v[16:17], v10 offset:0
    ds_read_b64_tr_b16 v[18:19], v10 offset:576
    ds_read_b128 v[20:23], v6 offset:3072
    s_waitcnt lgkmcnt(9)
    v_mfma_f32_32x32x16_bf16 v[48:63], v[24:27], v[28:31], v[48:63]
    ds_read_b64_tr_b16 v[24:25], v10 offset:2304
    ds_read_b64_tr_b16 v[26:27], v10 offset:2880
    ds_read_b128 v[28:31], v7 offset:3072
    s_waitcnt lgkmcnt(9)
    v_mfma_f32_32x32x16_bf16 v[48:63], v[32:35], v[36:39], v[48:63]
    ds_read_b64_tr_b16 v[32:33], v10 offset:4608
    ds_read_b64_tr_b16 v[34:35], v10 offset:5184
    ds_read_b128 v[36:39], v8 offset:3072
    s_waitcnt lgkmcnt(9)
    v_mfma_f32_32x32x16_bf16 v[48:63], v[40:43], v[44:47], v[48:63]
    ds_read_b64_tr_b16 v[40:41], v10 offset:6912
    ds_read_b64_tr_b16 v[42:43], v10 offset:7488
    ds_read_b128 v[44:47], v9 offset:3072
    s_mov_b64 exec, 1
    ds_add_u32 v2, v3 offset:28
    s_mov_b64 exec, -1
    s_waitcnt lgkmcnt(10)
    v_mfma_f32_32x32x16_bf16 v[48:63], v[16:19], v[20:23], v[48:63]
    ds_read_b64_tr_b16 v[16:17], v10 offset:9216
    ds_read_b64_tr_b16 v[18:19], v10 offset:9792
    ds_read_b128 v[20:23], v6 offset:4096
    s_waitcnt lgkmcnt(10)
    v_mfma_f32_32x32x16_bf16 v[48:63], v[24:27], v[28:31], v[48:63]
    ds_read_b64_tr_b16 v[24:25], v10 offset:11520
    ds_read_b64_tr_b16 v[26:27], v10 offset:12096
    ds_read_b128 v[28:31], v7 offset:4096
    s_waitcnt lgkmcnt(10)
    v_mfma_f32_32x32x16_bf16 v[48:63], v[32:35], v[36:39], v[48:63]
    ds_read_b64_tr_b16 v[32:33], v10 offset:13824
    ds_read_b64_tr_b16 v[34:35], v10 offset:14400
    ds_read_b128 v[36:39], v8 offset:4096
    s_waitcnt lgkmcnt(10)
    v_mfma_f32_32x32x16_bf16 v[48:63], v[40:43], v[44:47], v[48:63]
    ds_read_b64_tr_b16 v[40:41], v10 offset:16128
    ds_read_b64_tr_b16 v[42:43], v10 offset:16704
    ds_read_b128 v[44:47], v9 offset:4096
    s_waitcnt lgkmcnt(9)
    v_mfma_f32_32x32x16_bf16 v[48:63], v[16:19], v[20:23], v[48:63]
    ds_read_b64_tr_b16 v[16:17], v10 offset:18432
    ds_read_b64_tr_b16 v[18:19], v10 offset:19008
    ds_read_b128 v[20:23], v6 offset:5120
    s_waitcnt lgkmcnt(9)
    v_mfma_f32_32x32x16_bf16 v[48:63], v[24:27], v[28:31], v[48:63]
    ds_read_b32 v99, v2 offset:20
    ds_read_b64_tr_b16 v[24:25], v10 offset:20736
    ds_read_b64_tr_b16 v[26:27], v10 offset:21312
    ds_read_b128 v[28:31], v7 offset:5120
    s_waitcnt lgkmcnt(10)
    v_mfma_f32_32x32x16_bf16 v[48:63], v[32:35], v[36:39], v[48:63]
    ds_read_b64_tr_b16 v[32:33], v10 offset:23040
    ds_read_b64_tr_b16 v[34:35], v10 offset:23616
    ds_read_b128 v[36:39], v8 offset:5120
    s_waitcnt lgkmcnt(10)
    v_mfma_f32_32x32x16_bf16 v[48:63], v[40:43], v[44:47], v[48:63]
    ds_read_b64_tr_b16 v[40:41], v10 offset:25344
    ds_read_b64_tr_b16 v[42:43], v10 offset:25920
    ds_read_b128 v[44:47], v9 offset:5120
    s_waitcnt lgkmcnt(10)
    v_mfma_f32_32x32x16_bf16 v[48:63], v[16:19], v[20:23], v[48:63]
    s_waitcnt lgkmcnt(9)
    v_readfirstlane_b32 s3, v99
    s_cmp_lt_u32 s3, 3
    s_cbranch_scc1 QS_9
QB_10:
    ds_read_b64_tr_b16 v[16:17], v11 offset:0
    ds_read_b64_tr_b16 v[18:19], v11 offset:576
    ds_read_b128 v[20:23], v6 offset:6144
    s_waitcnt lgkmcnt(9)
    v_mfma_f32_32x32x16_bf16 v[48:63], v[24:27], v[28:31], v[48:63]
    ds_read_b64_tr_b16 v[24:25], v11 offset:2304
    ds_read_b64_tr_b16 v[26:27], v11 offset:2880
    ds_read_b128 v[28:31], v7 offset:6144
    s_waitcnt lgkmcnt(9)
    v_mfma_f32_32x32x16_bf16 v[48:63], v[32:35], v[36:39], v[48:63]
    ds_read_b64_tr_b16 v[32:33], v11 offset:4608
    ds_read_b64_tr_b16 v[34:35], v11 offset:5184
    ds_read_b128 v[36:39], v8 offset:6144
    s_waitcnt lgkmcnt(9)
    v_mfma_f32_32x32x16_bf16 v[48:63], v[40:43], v[44:47], v[48:63]
    ds_read_b64_tr_b16 v[40:41], v11 offset:6912
    ds_read_b64_tr_b16 v[42:43], v11 offset:7488
    ds_read_b128 v[44:47], v9 offset:6144
    s_mov_b64 exec, 1
    ds_add_u32 v2, v3 offset:32
    s_mov_b64 exec, -1
    s_waitcnt lgkmcnt(10)
    v_mfma_f32_32x32x16_bf16 v[48:63], v[16:19], v[20:23], v[48:63]
    ds_read_b64_tr_b16 v[16:17], v11 offset:9216
    ds_read_b64_tr_b16 v[18:19], v11 offset:9792
    ds_read_b128 v[20:23], v6 offset:7168
    s_waitcnt lgkmcnt(10)
    v_mfma_f32_32x32x16_bf16 v[48:63], v[24:27], v[28:31], v[48:63]
    ds_read_b64_tr_b16 v[24:25], v11 offset:11520
    ds_read_b64_tr_b16 v[26:27], v11 offset:12096
    ds_read_b128 v[28:31], v7 offset:7168
    s_waitcnt lgkmcnt(10)
    v_mfma_f32_32x32x16_bf16 v[48:63], v[32:35], v[36:39], v[48:63]
    ds_read_b64_tr_b16 v[32:33], v11 offset:13824
    ds_read_b64_tr_b16 v[34:35], v11 offset:14400
    ds_read_b128 v[36:39], v8 offset:7168
    s_waitcnt lgkmcnt(10)
    v_mfma_f32_32x32x16_bf16 v[48:63], v[40:43], v[44:47], v[48:63]
    ds_read_b64_tr_b16 v[40:41], v11 offset:16128
    ds_read_b64_tr_b16 v[42:43], v11 offset:16704
    ds_read_b128 v[44:47], v9 offset:7168
    s_waitcnt lgkmcnt(9)
    v_mfma_f32_32x32x16_bf16 v[48:63], v[16:19], v[20:23], v[48:63]
    ds_read_b64_tr_b16 v[16:17], v11 offset:18432
    ds_read_b64_tr_b16 v[18:19], v11 offset:19008
    ds_read_b128 v[20:23], v6 offset:8192
    s_waitcnt lgkmcnt(9)
    v_mfma_f32_32x32x16_bf16 v[48:63], v[24:27], v[28:31], v[48:63]
    ds_read_b64_tr_b16 v[24:25], v11 offset:20736
    ds_read_b64_tr_b16 v[26:27], v11 offset:21312
    ds_read_b128 v[28:31], v7 offset:8192
    s_waitcnt lgkmcnt(9)
    v_mfma_f32_32x32x16_bf16 v[48:63], v[32:35], v[36:39], v[48:63]
    ds_read_b64_tr_b16 v[32:33], v11 offset:23040
    ds_read_b64_tr_b16 v[34:35], v11 offset:23616
    ds_read_b128 v[36:39], v8 offset:8192
    s_waitcnt lgkmcnt(9)
    v_mfma_f32_32x32x16_bf16 v[48:63], v[40:43], v[44:47], v[48:63]
    ds_read_b64_tr_b16 v[40:41], v11 offset:25344
    ds_read_b64_tr_b16 v[42:43], v11 offset:25920
    ds_read_b128 v[44:47], v9 offset:8192
    s_waitcnt lgkmcnt(9)
    v_mfma_f32_32x32x16_bf16 v[48:63], v[16:19], v[20:23], v[48:63]
    s_waitcnt lgkmcnt(6)
    v_mfma_f32_32x32x16_bf16 v[48:63], v[24:27], v[28:31], v[48:63]
    s_waitcnt lgkmcnt(3)
    v_mfma_f32_32x32x16_bf16 v[48:63], v[32:35], v[36:39], v[48:63]
    s_waitcnt lgkmcnt(0)
    v_mfma_f32_32x32x16_bf16 v[48:63], v[40:43], v[44:47], v[48:63]
    s_mov_b64 exec, 1
    ds_add_u32 v2, v3 offset:36
    s_mov_b64 exec, -1
    s_nop 8
    s_mov_b32 s10, 0x3eae1a93
    s_bitcmp1_b32 s72, 0
    s_cbranch_scc0 L_a_qeven
    v_mul_f32 v16, s10, v50
    v_mul_f32 v17, s10, v51
    v_mul_f32 v18, s10, v52
    v_mul_f32 v19, s10, v53
    v_mul_f32 v20, s10, v54
    v_mul_f32 v21, s10, v55
    v_mul_f32 v22, s10, v56
    v_mul_f32 v23, s10, v57
    v_mul_f32 v24, s10, v62
    v_mul_f32 v25, s10, v63
    s_branch L_a_qj
L_a_qeven:
    v_mul_f32 v16, s10, v48
    v_mul_f32 v17, s10, v49
    v_mul_f32 v18, s10, v50
    v_mul_f32 v19, s10, v51
    v_mul_f32 v20, s10, v52
    v_mul_f32 v21, s10, v53
    v_mul_f32 v22, s10, v54
    v_mul_f32 v23, s10, v55
    v_mul_f32 v24, s10, v56
    v_mul_f32 v25, s10, v57
L_a_qj:
    v_cmp_gt_u32 vcc, 32, v1
    s_nop 1
    v_cndmask_b32 v24, 0, v24, vcc
    v_cndmask_b32 v25, 0, v25, vcc
    v_cvt_pk_bf16_f32 v72, v16, v17
    v_cvt_pk_bf16_f32 v73, v18, v19
    v_cvt_pk_bf16_f32 v74, v20, v21
    v_cvt_pk_bf16_f32 v75, v22, v23
    v_cvt_pk_bf16_f32 v76, v24, v25
    v_mov_b32 v77, 0
    v_mul_f32 v104, v16, v16
    v_fmac_f32 v104, v17, v17
    v_fmac_f32 v104, v18, v18
    v_fmac_f32 v104, v19, v19
    v_fmac_f32 v104, v20, v20
    v_fmac_f32 v104, v21, v21
    v_fmac_f32 v104, v22, v22
    v_fmac_f32 v104, v23, v23
    v_fmac_f32 v104, v24, v24
    v_fmac_f32 v104, v25, v25
    v_mov_b32 v105, v104
    s_nop 1
    v_permlane32_swap_b32 v104, v105
    s_nop 1
    v_add_f32 v104, v104, v105
    s_mov_b32 exec_hi, 0
    ds_max_u32 v2, v104 offset:48
    s_mov_b64 exec, -1
    s_mov_b32 s74, 0
    s_mov_b32 s75, 1
    s_mov_b32 s79, 0
    s_cmp_eq_u32 s73, 0
    s_cselect_b32 s16, 3, 6
    s_cselect_b32 s17, 9, 13
    s_lshl_b32 s10, s5, 3
    s_add_u32 s18, s10, s6
    s_lshl_b32 s18, s18, 1
    s_add_u32 s18, s18, s73
    s_lshl_b32 s18, s18, 7
    s_add_u32 s18, s18, 8257536
L_pass:
    v_mov_b32 v48, 0
    v_mov_b32 v49, 0
    v_mov_b32 v50, 0
    v_mov_b32 v51, 0
    v_mov_b32 v52, 0
    v_mov_b32 v53, 0
    v_mov_b32 v54, 0
    v_mov_b32 v55, 0
    v_mov_b32 v56, 0
    v_mov_b32 v57, 0
    v_mov_b32 v58, 0
    v_mov_b32 v59, 0
    v_mov_b32 v60, 0
    v_mov_b32 v61, 0
    v_mov_b32 v62, 0
    v_mov_b32 v63, 0
    v_mov_b32 v68, 0
    v_mov_b32 v92, 0
    v_mov_b32 v69, 0
    v_mov_b32 v93, 0
    v_mov_b32 v70, 0
    v_mov_b32 v94, 0
    v_mov_b32 v71, 0
    v_mov_b32 v95, 0
    s_add_u32 s10, s74, 1
W_11:
    ds_read_b32 v4, v2 offset:40
    s_waitcnt lgkmcnt(0)
    v_readfirstlane_b32 s3, v4
    s_cmp_ge_u32 s3, s10
    s_cbranch_scc1 WD_12
    s_sub_u32 s8, s8, 1
    s_cselect_b32 s8, 0, s8
    s_cbranch_scc1 WD_12
    s_sleep 0
    s_branch W_11
WD_12:
    v_mov_b32 v99, s3
    ds_read_b128 v[84:87], v97 offset:4608
    ds_read_b128 v[80:83], v96
    ds_read_b32 v4, v2 offset:44
    s_mov_b32 s77, 0
    s_setprio 2
    s_waitcnt lgkmcnt(0)
    v_mfma_f32_32x32x8_bf16 v[16:31], v[84:85], v[76:77], 0
    v_mfma_f32_32x32x16_bf16 v[16:31], v[80:83], v[72:75], v[16:31]
    ds_read_b128 v[80:83], v96 offset:1024
    ds_read_b128 v[88:91], v98
    v_readfirstlane_b32 s9, v4
    s_nop 7
.p2align 5
L_att:
    s_waitcnt lgkmcnt(2)
    v_mfma_f32_32x32x8_bf16 v[32:47], v[86:87], v[76:77], 0
    ds_read_b128 v[84:87], v97 offset:9728
    v_exp_f32 v16, v16
    v_exp_f32 v17, v17
    v_exp_f32 v18, v18
    v_exp_f32 v19, v19
    v_mfma_f32_32x32x16_bf16 v[48:63], v[92:95], v[68:71], v[48:63]
    ds_read_b128 v[92:95], v98 offset:640
    s_lshl_b32 s10, s77, 1
    s_cmp_eq_u32 s10, s16
    s_cbranch_scc0 PR_13
    s_setprio 1
PR_13:
    s_cmp_eq_u32 s10, s17
    s_cbranch_scc0 PR_14
    s_setprio 0
PR_14:
    v_cvt_pk_bf16_f32 v64, v16, v17
    v_cvt_pk_bf16_f32 v65, v18, v19
    v_mov_b32 v101, s74
    v_exp_f32 v20, v20
    v_exp_f32 v21, v21
    v_exp_f32 v22, v22
    v_exp_f32 v23, v23
    s_waitcnt lgkmcnt(2)
    v_mfma_f32_32x32x16_bf16 v[32:47], v[80:83], v[72:75], v[32:47]
    ds_read_b128 v[80:83], v96 offset:5120
    v_cvt_pk_bf16_f32 v66, v20, v21
    v_cvt_pk_bf16_f32 v67, v22, v23
    v_exp_f32 v24, v24
    v_exp_f32 v25, v25
    v_exp_f32 v26, v26
    v_exp_f32 v27, v27
    v_mfma_f32_32x32x16_bf16 v[48:63], v[88:91], v[64:67], v[48:63]
    ds_read_b128 v[88:91], v98 offset:1280
    v_cvt_pk_bf16_f32 v68, v24, v25
    v_cvt_pk_bf16_f32 v69, v26, v27
    v_exp_f32 v28, v28
    v_exp_f32 v29, v29
    v_exp_f32 v30, v30
    v_exp_f32 v31, v31
    v_cvt_pk_bf16_f32 v70, v28, v29
    v_cvt_pk_bf16_f32 v71, v30, v31
    s_waitcnt lgkmcnt(2)
    v_mfma_f32_32x32x8_bf16 v[16:31], v[84:85], v[76:77], 0
    s_mov_b64 exec, 1
    ds_write_b32 v100, v101
    s_mov_b64 exec, -1
    v_exp_f32 v32, v32
    v_exp_f32 v33, v33
    v_exp_f32 v34, v34
    v_exp_f32 v35, v35
    v_mfma_f32_32x32x16_bf16 v[48:63], v[92:95], v[68:71], v[48:63]
    ds_read_b128 v[92:95], v98 offset:1920
    s_add_u32 s78, s74, 2
    v_cvt_pk_bf16_f32 v64, v32, v33
    v_cvt_pk_bf16_f32 v65, v34, v35
    v_exp_f32 v36, v36
    v_exp_f32 v37, v37
    v_exp_f32 v38, v38
    v_exp_f32 v39, v39
    s_waitcnt lgkmcnt(2)
    v_mfma_f32_32x32x16_bf16 v[16:31], v[80:83], v[72:75], v[16:31]
    ds_read_b128 v[80:83], v96 offset:6144
    v_cvt_pk_bf16_f32 v66, v36, v37
    v_cvt_pk_bf16_f32 v67, v38, v39
    v_exp_f32 v40, v40
    v_exp_f32 v41, v41
    v_exp_f32 v42, v42
    v_exp_f32 v43, v43
    v_mfma_f32_32x32x16_bf16 v[48:63], v[88:91], v[64:67], v[48:63]
    ds_read_b128 v[88:91], v98 offset:5120
    v_cvt_pk_bf16_f32 v68, v40, v41
    v_cvt_pk_bf16_f32 v69, v42, v43
    v_readfirstlane_b32 s3, v99
    v_exp_f32 v44, v44
    v_exp_f32 v45, v45
    v_exp_f32 v46, v46
    v_exp_f32 v47, v47
    v_cvt_pk_bf16_f32 v70, v44, v45
    v_cvt_pk_bf16_f32 v71, v46, v47
    s_cmp_lt_u32 s3, s78
    s_cbranch_scc1 L_att_slow1
L_att_back1:
    s_waitcnt lgkmcnt(2)
    v_mfma_f32_32x32x8_bf16 v[32:47], v[86:87], v[76:77], 0
    ds_read_b128 v[84:87], v97 offset:14848
    v_exp_f32 v16, v16
    v_exp_f32 v17, v17
    v_exp_f32 v18, v18
    v_exp_f32 v19, v19
    v_mfma_f32_32x32x16_bf16 v[48:63], v[92:95], v[68:71], v[48:63]
    ds_read_b128 v[92:95], v98 offset:5760
    s_sub_u32 s75, s75, 1
    s_mov_b32 s76, 0xffffb000
    s_cselect_b32 s76, 40960, s76
    s_cselect_b32 s75, 2, s75
    v_cvt_pk_bf16_f32 v64, v16, v17
    v_cvt_pk_bf16_f32 v65, v18, v19
    v_exp_f32 v20, v20
    v_exp_f32 v21, v21
    v_exp_f32 v22, v22
    v_exp_f32 v23, v23
    s_waitcnt lgkmcnt(2)
    v_mfma_f32_32x32x16_bf16 v[32:47], v[80:83], v[72:75], v[32:47]
    ds_read_b128 v[80:83], v96 offset:10240
    v_cvt_pk_bf16_f32 v66, v20, v21
    v_cvt_pk_bf16_f32 v67, v22, v23
    v_exp_f32 v24, v24
    v_exp_f32 v25, v25
    v_exp_f32 v26, v26
    v_exp_f32 v27, v27
    v_mfma_f32_32x32x16_bf16 v[48:63], v[88:91], v[64:67], v[48:63]
    ds_read_b128 v[88:91], v98 offset:6400
    v_cvt_pk_bf16_f32 v68, v24, v25
    v_cvt_pk_bf16_f32 v69, v26, v27
    v_exp_f32 v28, v28
    v_exp_f32 v29, v29
    v_exp_f32 v30, v30
    v_exp_f32 v31, v31
    v_cvt_pk_bf16_f32 v70, v28, v29
    v_cvt_pk_bf16_f32 v71, v30, v31
    s_waitcnt lgkmcnt(2)
    v_mfma_f32_32x32x8_bf16 v[16:31], v[84:85], v[76:77], 0
    ds_read_b32 v99, v2 offset:40
    v_exp_f32 v32, v32
    v_exp_f32 v33, v33
    v_exp_f32 v34, v34
    v_exp_f32 v35, v35
    v_mfma_f32_32x32x16_bf16 v[48:63], v[92:95], v[68:71], v[48:63]
    ds_read_b128 v[92:95], v98 offset:7040
    s_add_u32 s74, s74, 1
    s_add_u32 s78, s74, 2
    s_cmp_eq_u32 s77, 7
    s_cselect_b32 s78, 0, s78
    v_cvt_pk_bf16_f32 v64, v32, v33
    v_cvt_pk_bf16_f32 v65, v34, v35
    v_exp_f32 v36, v36
    v_exp_f32 v37, v37
    v_exp_f32 v38, v38
    v_exp_f32 v39, v39
    s_waitcnt lgkmcnt(2)
    v_mfma_f32_32x32x16_bf16 v[16:31], v[80:83], v[72:75], v[16:31]
    ds_read_b128 v[80:83], v96 offset:11264
    v_cvt_pk_bf16_f32 v66, v36, v37
    v_cvt_pk_bf16_f32 v67, v38, v39
    v_exp_f32 v40, v40
    v_exp_f32 v41, v41
    v_exp_f32 v42, v42
    v_exp_f32 v43, v43
    v_mfma_f32_32x32x16_bf16 v[48:63], v[88:91], v[64:67], v[48:63]
    ds_read_b128 v[88:91], v98 offset:10240
    v_cvt_pk_bf16_f32 v68, v40, v41
    v_cvt_pk_bf16_f32 v69, v42, v43
    v_exp_f32 v44, v44
    v_exp_f32 v45, v45
    v_exp_f32 v46, v46
    v_exp_f32 v47, v47
    v_cvt_pk_bf16_f32 v70, v44, v45
    v_cvt_pk_bf16_f32 v71, v46, v47
    s_waitcnt lgkmcnt(2)
    v_mfma_f32_32x32x8_bf16 v[32:47], v[86:87], v[76:77], 0
    ds_read_b128 v[84:87], v97 offset:19968
    v_exp_f32 v16, v16
    v_exp_f32 v17, v17
    v_exp_f32 v18, v18
    v_exp_f32 v19, v19
    v_mfma_f32_32x32x16_bf16 v[48:63], v[92:95], v[68:71], v[48:63]
    ds_read_b128 v[92:95], v98 offset:10880
    s_lshl_b32 s10, s77, 1
    s_add_u32 s10, s10, 1
    s_cmp_eq_u32 s10, s16
    s_cbranch_scc0 PR_15
    s_setprio 1
PR_15:
    s_cmp_eq_u32 s10, s17
    s_cbranch_scc0 PR_16
    s_setprio 0
PR_16:
    v_cvt_pk_bf16_f32 v64, v16, v17
    v_cvt_pk_bf16_f32 v65, v18, v19
    v_mov_b32 v101, s74
    v_exp_f32 v20, v20
    v_exp_f32 v21, v21
    v_exp_f32 v22, v22
    v_exp_f32 v23, v23
    s_waitcnt lgkmcnt(2)
    v_mfma_f32_32x32x16_bf16 v[32:47], v[80:83], v[72:75], v[32:47]
    ds_read_b128 v[80:83], v96 offset:15360
    v_cvt_pk_bf16_f32 v66, v20, v21
    v_cvt_pk_bf16_f32 v67, v22, v23
    v_exp_f32 v24, v24
    v_exp_f32 v25, v25
    v_exp_f32 v26, v26
    v_exp_f32 v27, v27
    v_mfma_f32_32x32x16_bf16 v[48:63], v[88:91], v[64:67], v[48:63]
    ds_read_b128 v[88:91], v98 offset:11520
    v_cvt_pk_bf16_f32 v68, v24, v25
    v_cvt_pk_bf16_f32 v69, v26, v27
    v_exp_f32 v28, v28
    v_exp_f32 v29, v29
    v_exp_f32 v30, v30
    v_exp_f32 v31, v31
    v_cvt_pk_bf16_f32 v70, v28, v29
    v_cvt_pk_bf16_f32 v71, v30, v31
    s_waitcnt lgkmcnt(2)
    v_mfma_f32_32x32x8_bf16 v[16:31], v[84:85], v[76:77], 0
    s_mov_b64 exec, 1
    ds_write_b32 v100, v101
    s_mov_b64 exec, -1
    v_exp_f32 v32, v32
    v_exp_f32 v33, v33
    v_exp_f32 v34, v34
    v_exp_f32 v35, v35
    v_mfma_f32_32x32x16_bf16 v[48:63], v[92:95], v[68:71], v[48:63]
    ds_read_b128 v[92:95], v98 offset:12160
    v_cvt_pk_bf16_f32 v64, v32, v33
    v_cvt_pk_bf16_f32 v65, v34, v35
    v_exp_f32 v36, v36
    v_exp_f32 v37, v37
    v_exp_f32 v38, v38
    v_exp_f32 v39, v39
    s_waitcnt lgkmcnt(2)
    v_mfma_f32_32x32x16_bf16 v[16:31], v[80:83], v[72:75], v[16:31]
    ds_read_b128 v[80:83], v96 offset:16384
    v_cvt_pk_bf16_f32 v66, v36, v37
    v_cvt_pk_bf16_f32 v67, v38, v39
    v_exp_f32 v40, v40
    v_exp_f32 v41, v41
    v_exp_f32 v42, v42
    v_exp_f32 v43, v43
    v_mfma_f32_32x32x16_bf16 v[48:63], v[88:91], v[64:67], v[48:63]
    ds_read_b128 v[88:91], v98 offset:15360
    v_cvt_pk_bf16_f32 v68, v40, v41
    v_cvt_pk_bf16_f32 v69, v42, v43
    v_readfirstlane_b32 s3, v99
    v_add_u32 v96, s76, v96
    v_add_u32 v97, s76, v97
    v_exp_f32 v44, v44
    v_exp_f32 v45, v45
    v_exp_f32 v46, v46
    v_exp_f32 v47, v47
    v_cvt_pk_bf16_f32 v70, v44, v45
    v_cvt_pk_bf16_f32 v71, v46, v47
    s_cmp_lt_u32 s3, s78
    s_cbranch_scc1 L_att_slow5
L_att_back5:
    s_waitcnt lgkmcnt(2)
    v_mfma_f32_32x32x8_bf16 v[32:47], v[86:87], v[76:77], 0
    ds_read_b128 v[84:87], v97 offset:4608
    v_exp_f32 v16, v16
    v_exp_f32 v17, v17
    v_exp_f32 v18, v18
    v_exp_f32 v19, v19
    v_mfma_f32_32x32x16_bf16 v[48:63], v[92:95], v[68:71], v[48:63]
    ds_read_b128 v[92:95], v98 offset:16000
    v_cvt_pk_bf16_f32 v64, v16, v17
    v_cvt_pk_bf16_f32 v65, v18, v19
    v_exp_f32 v20, v20
    v_exp_f32 v21, v21
    v_exp_f32 v22, v22
    v_exp_f32 v23, v23
    s_waitcnt lgkmcnt(2)
    v_mfma_f32_32x32x16_bf16 v[32:47], v[80:83], v[72:75], v[32:47]
    ds_read_b128 v[80:83], v96 offset:0
    v_cvt_pk_bf16_f32 v66, v20, v21
    v_cvt_pk_bf16_f32 v67, v22, v23
    v_exp_f32 v24, v24
    v_exp_f32 v25, v25
    v_exp_f32 v26, v26
    v_exp_f32 v27, v27
    v_mfma_f32_32x32x16_bf16 v[48:63], v[88:91], v[64:67], v[48:63]
    ds_read_b128 v[88:91], v98 offset:16640
    v_cvt_pk_bf16_f32 v68, v24, v25
    v_cvt_pk_bf16_f32 v69, v26, v27
    v_exp_f32 v28, v28
    v_exp_f32 v29, v29
    v_exp_f32 v30, v30
    v_exp_f32 v31, v31
    v_cvt_pk_bf16_f32 v70, v28, v29
    v_cvt_pk_bf16_f32 v71, v30, v31
    s_waitcnt lgkmcnt(2)
    v_mfma_f32_32x32x8_bf16 v[16:31], v[84:85], v[76:77], 0
    ds_read_b32 v99, v2 offset:40
    v_exp_f32 v32, v32
    v_exp_f32 v33, v33
    v_exp_f32 v34, v34
    v_exp_f32 v35, v35
    v_mfma_f32_32x32x16_bf16 v[48:63], v[92:95], v[68:71], v[48:63]
    ds_read_b128 v[92:95], v98 offset:17280
    v_cvt_pk_bf16_f32 v64, v32, v33
    v_cvt_pk_bf16_f32 v65, v34, v35
    v_add_u32 v98, s76, v98
    v_exp_f32 v36, v36
    v_exp_f32 v37, v37
    v_exp_f32 v38, v38
    v_exp_f32 v39, v39
    s_waitcnt lgkmcnt(2)
    v_mfma_f32_32x32x16_bf16 v[16:31], v[80:83], v[72:75], v[16:31]
    ds_read_b128 v[80:83], v96 offset:1024
    v_cvt_pk_bf16_f32 v66, v36, v37
    v_cvt_pk_bf16_f32 v67, v38, v39
    v_exp_f32 v40, v40
    v_exp_f32 v41, v41
    v_exp_f32 v42, v42
    v_exp_f32 v43, v43
    v_mfma_f32_32x32x16_bf16 v[48:63], v[88:91], v[64:67], v[48:63]
    ds_read_b128 v[88:91], v98 offset:0
    s_add_u32 s74, s74, 1
    s_add_u32 s77, s77, 1
    s_cmp_lt_u32 s77, 8
    v_cvt_pk_bf16_f32 v68, v40, v41
    v_cvt_pk_bf16_f32 v69, v42, v43
    v_exp_f32 v44, v44
    v_exp_f32 v45, v45
    v_exp_f32 v46, v46
    v_exp_f32 v47, v47
    v_cvt_pk_bf16_f32 v70, v44, v45
    v_cvt_pk_bf16_f32 v71, v46, v47
    s_cbranch_scc1 L_att
    ds_read_b32 v4, v2 offset:80
    ds_read_b32 v106, v2 offset:72
    s_waitcnt lgkmcnt(0)
    v_mfma_f32_32x32x16_bf16 v[48:63], v[92:95], v[68:71], v[48:63]
    v_mov_b32 v99, s74
    s_mov_b64 exec, 1
    ds_write_b32 v100, v99
    s_mov_b64 exec, -1
    s_setprio 3
    v_readfirstlane_b32 s3, v4
    v_cmp_gt_u32 vcc, 32, v1
    s_cmp_gt_u32 s3, s79
    s_cbranch_scc1 L_maxpass
    v_readfirstlane_b32 s3, v106
    s_cmp_eq_u32 s3, 0
    s_cbranch_scc1 L_o_slow
L_o_back:
    s_lshl_b32 s13, s5, 3
    s_add_u32 s13, s13, s6
    s_mul_i32 s13, s13, 9216
    s_mul_i32 s10, s73, 4608
    s_add_u32 s13, s13, s10
    s_add_u32 s13, s13, 4980736
    v_cndmask_b32 v104, v60, v58, vcc
    v_rcp_f32 v104, v104
    s_lshl_b32 s10, s73, 2
    v_mul_f32 v48, v48, v104
    v_mul_f32 v49, v49, v104
    v_mul_f32 v50, v50, v104
    v_mul_f32 v51, v51, v104
    v_mul_f32 v52, v52, v104
    v_mul_f32 v53, v53, v104
    v_mul_f32 v54, v54, v104
    v_mul_f32 v55, v55, v104
    v_mul_f32 v56, v56, v104
    v_mul_f32 v57, v57, v104
    v_cvt_pk_bf16_f32 v64, v48, v49
    v_cvt_pk_bf16_f32 v65, v50, v51
    v_cvt_pk_bf16_f32 v66, v52, v53
    v_cvt_pk_bf16_f32 v67, v54, v55
    v_cvt_pk_bf16_f32 v68, v56, v57
    v_add_u32 v105, s10, v2
    ds_write_b128 v12, v[64:67]
    s_mov_b64 exec, vcc
    ds_write_b32 v13, v68
    s_mov_b64 exec, 1
    s_waitcnt lgkmcnt(0)
    ds_add_rtn_u32 v4, v105, v3 offset:116
    s_mov_b64 exec, -1
    s_waitcnt lgkmcnt(0)
    v_readfirstlane_b32 s3, v4
    s_cmp_eq_u32 s3, 3
    s_cbranch_scc0 L_o_pub
    ds_read_b128 v[16:19], v15 offset:0
    ds_read_b128 v[20:23], v15 offset:1024
    ds_read_b128 v[24:27], v15 offset:2048
    ds_read_b128 v[28:31], v15 offset:3072
    ds_read_b128 v[32:35], v15 offset:4096
    s_waitcnt lgkmcnt(4)
    buffer_store_dwordx4 v[16:19], v14, s[20:23], s13 offen offset:0 sc1
    s_waitcnt lgkmcnt(3)
    buffer_store_dwordx4 v[20:23], v14, s[20:23], s13 offen offset:1024 sc1
    s_waitcnt lgkmcnt(2)
    buffer_store_dwordx4 v[24:27], v14, s[20:23], s13 offen offset:2048 sc1
    s_waitcnt lgkmcnt(1)
    buffer_store_dwordx4 v[28:31], v14, s[20:23], s13 offen offset:3072 sc1
    s_waitcnt lgkmcnt(0)
    s_mov_b32 exec_hi, 0
    s_add_u32 s13, s13, 4096
    buffer_store_dwordx4 v[32:35], v14, s[20:23], s13 offen offset:0 sc1
    s_mov_b64 exec, 1
    v_mov_b32 v104, s9
    v_mov_b32 v106, 0
    s_waitcnt vmcnt(0)
    buffer_store_dword v104, v106, s[20:23], s18 offen sc1
    s_mov_b64 exec, 1
    ds_add_u32 v2, v3 offset:100
    s_mov_b64 exec, -1
L_o_pub:
L_oproj:
    s_and_b32 s74, s4, 3
    s_lshr_b32 s75, s4, 2
    s_lshl_b32 s75, s75, 5
    s_lshl_b32 s10, s74, 4
    s_cmp_ge_u32 s4, 8
    s_cselect_b32 s75, s10, s75
    s_cselect_b32 s74, 4, s74
    v_lshrrev_b32 v107, 4, v1
    v_bfe_u32 v104, v1, 2, 2
    v_and_b32 v105, 3, v1
    v_mul_u32_u24 v104, 144, v104
    v_lshl_add_u32 v104, v105, 3, v104
    s_lshl_b32 s10, s74, 5
    v_add_u32 v104, s10, v104
    v_and_b32 v105, 1, v107
    v_lshrrev_b32 v106, 1, v107
    v_mul_u32_u24 v121, 10368, v105
    v_mul_u32_u24 v122, 4608, v106
    v_add3_u32 v121, v121, v122, v104
    v_mul_u32_u24 v122, 10368, v107
    v_add_u32 v122, v122, v104
    v_add_u32 v123, 41472, v121
    s_setprio 0
W_17:
    ds_read_b32 v4, v2 offset:84
    s_waitcnt lgkmcnt(0)
    v_readfirstlane_b32 s3, v4
    s_cmp_ge_u32 s3, 1
    s_cbranch_scc1 WD_18
    s_sub_u32 s8, s8, 1
    s_cselect_b32 s8, 0, s8
    s_cbranch_scc1 WD_18
    s_sleep 8
    s_branch W_17
WD_18:
    s_setprio 3
    ds_read_b64_tr_b16 v[16:17], v121 offset:0
    ds_read_b64_tr_b16 v[18:19], v121 offset:576
    ds_read_b64_tr_b16 v[20:21], v121 offset:1152
    ds_read_b64_tr_b16 v[22:23], v121 offset:1728
    ds_read_b64_tr_b16 v[24:25], v121 offset:2304
    ds_read_b64_tr_b16 v[26:27], v121 offset:2880
    ds_read_b64_tr_b16 v[28:29], v121 offset:3456
    ds_read_b64_tr_b16 v[30:31], v121 offset:4032
    ds_read_b64_tr_b16 v[32:33], v121 offset:20736
    ds_read_b64_tr_b16 v[34:35], v121 offset:21312
    ds_read_b64_tr_b16 v[36:37], v121 offset:21888
    ds_read_b64_tr_b16 v[38:39], v121 offset:22464
    s_waitcnt lgkmcnt(3)
    ds_read_b64_tr_b16 v[40:41], v121 offset:23040
    ds_read_b64_tr_b16 v[42:43], v121 offset:23616
    ds_read_b64_tr_b16 v[44:45], v121 offset:24192
    ds_read_b64_tr_b16 v[46:47], v121 offset:24768
    ds_read_b64_tr_b16 v[48:49], v123 offset:0
    ds_read_b64_tr_b16 v[50:51], v123 offset:576
    ds_read_b64_tr_b16 v[52:53], v123 offset:1152
    ds_read_b64_tr_b16 v[54:55], v123 offset:1728
    ds_read_b64_tr_b16 v[56:57], v123 offset:2304
    ds_read_b64_tr_b16 v[58:59], v123 offset:2880
    ds_read_b64_tr_b16 v[60:61], v123 offset:3456
    ds_read_b64_tr_b16 v[62:63], v123 offset:4032
    s_waitcnt lgkmcnt(3)
    ds_read_b64_tr_b16 v[64:65], v123 offset:20736
    ds_read_b64_tr_b16 v[66:67], v123 offset:21312
    ds_read_b64_tr_b16 v[68:69], v123 offset:21888
    ds_read_b64_tr_b16 v[70:71], v123 offset:22464
    ds_read_b64_tr_b16 v[72:73], v123 offset:23040
    ds_read_b64_tr_b16 v[74:75], v123 offset:23616
    ds_read_b64_tr_b16 v[76:77], v123 offset:24192
    ds_read_b64_tr_b16 v[78:79], v123 offset:24768
    ds_read_b64_tr_b16 v[80:81], v122 offset:9216
    ds_read_b64_tr_b16 v[82:83], v122 offset:9792
    ds_read_b64_tr_b16 v[84:85], v122 offset:50688
    ds_read_b64_tr_b16 v[86:87], v122 offset:51264
    s_waitcnt lgkmcnt(3)
    v_and_b32 v104, 15, v1
    v_add_u32 v104, s75, v104
    v_mul_u32_u24 v124, 144, v104
    v_add_u32 v124, 82944, v124
    v_mul_u32_u24 v105, 9216, v105
    v_lshl_add_u32 v105, v106, 6, v105
    v_mul_u32_u24 v106, 9216, v107
    s_waitcnt lgkmcnt(0)
    v_add_u32 v120, v124, v105
    v_add_u32 v121, v124, v106
    v_lshlrev_b32 v122, 4, v1
    s_lshl_b32 s11, s5, 6
    v_add_u32 v105, s11, v104
    v_mul_u32_u24 v105, 2304, v105
    v_lshl_add_u32 v123, v107, 3, v105
    s_mul_i32 s14, s6, 144
    s_lshl_b32 s10, s74, 5
    s_add_u32 s14, s14, s10
    s_add_u32 s15, s14, 36864
    s_mul_i32 s13, s5, 73728
    s_lshl_b32 s10, s4, 10
    s_add_u32 s13, s13, s10
    s_add_u32 s13, s13, 4980736
    s_add_u32 s12, s10, 82944
    s_cmp_ge_u32 s4, 8
    s_cbranch_scc1 L_o_half
W_19:
    ds_read_b32 v4, v2 offset:104
    s_waitcnt lgkmcnt(0)
    v_readfirstlane_b32 s3, v4
    s_cmp_ge_u32 s3, 1
    s_cbranch_scc1 WD_20
    s_sub_u32 s8, s8, 1
    s_cselect_b32 s8, 0, s8
    s_cbranch_scc1 WD_20
    s_sleep 0
    s_branch W_19
WD_20:
    s_add_u32 m0, s12, 0
    s_nop 0
    buffer_load_dwordx4 v122, s[20:23], s13 offen sc1 lds
    s_add_u32 s13, s13, 8192
    s_add_u32 m0, s12, 8192
    s_nop 0
    buffer_load_dwordx4 v122, s[20:23], s13 offen sc1 lds
    s_add_u32 s13, s13, 8192
    s_add_u32 m0, s12, 16384
    s_nop 0
    buffer_load_dwordx4 v122, s[20:23], s13 offen sc1 lds
    s_add_u32 s13, s13, 8192
    s_add_u32 m0, s12, 24576
    s_nop 0
    buffer_load_dwordx4 v122, s[20:23], s13 offen sc1 lds
    s_add_u32 s13, s13, 8192
    s_add_u32 m0, s12, 32768
    s_nop 0
    buffer_load_dwordx4 v122, s[20:23], s13 offen sc1 lds
    s_add_u32 s13, s13, 8192
    s_add_u32 m0, s12, 40960
    s_nop 0
    buffer_load_dwordx4 v122, s[20:23], s13 offen sc1 lds
    s_add_u32 s13, s13, 8192
    s_add_u32 m0, s12, 49152
    s_nop 0
    buffer_load_dwordx4 v122, s[20:23], s13 offen sc1 lds
    s_add_u32 s13, s13, 8192
    s_add_u32 m0, s12, 57344
    s_nop 0
    buffer_load_dwordx4 v122, s[20:23], s13 offen sc1 lds
    s_add_u32 s13, s13, 8192
    s_add_u32 m0, s12, 65536
    s_nop 0
    buffer_load_dwordx4 v122, s[20:23], s13 offen sc1 lds
    s_waitcnt vmcnt(6)
    s_barrier
    ds_read_b128 v[96:99], v120 offset:0
    ds_read_b128 v[100:103], v120 offset:2304
    ds_read_b128 v[104:107], v120 offset:16
    ds_read_b128 v[108:111], v120 offset:2320
    ds_read_b128 v[112:115], v120 offset:32
    ds_read_b128 v[116:119], v120 offset:2336
    s_waitcnt lgkmcnt(5)
    v_mfma_f32_16x16x32_bf16 v[88:91], v[16:19], v[96:99], 0
    s_waitcnt lgkmcnt(4)
    v_mfma_f32_16x16x32_bf16 v[92:95], v[16:19], v[100:103], 0
    ds_read_b128 v[96:99], v120 offset:48
    ds_read_b128 v[100:103], v120 offset:2352
    s_waitcnt lgkmcnt(5)
    v_mfma_f32_16x16x32_bf16 v[88:91], v[20:23], v[104:107], v[88:91]
    s_waitcnt lgkmcnt(4)
    v_mfma_f32_16x16x32_bf16 v[92:95], v[20:23], v[108:111], v[92:95]
    s_waitcnt lgkmcnt(3)
    v_mfma_f32_16x16x32_bf16 v[88:91], v[24:27], v[112:115], v[88:91]
    s_waitcnt lgkmcnt(2)
    v_mfma_f32_16x16x32_bf16 v[92:95], v[24:27], v[116:119], v[92:95]
    s_waitcnt lgkmcnt(1)
    v_mfma_f32_16x16x32_bf16 v[88:91], v[28:31], v[96:99], v[88:91]
    s_waitcnt lgkmcnt(0)
    v_mfma_f32_16x16x32_bf16 v[92:95], v[28:31], v[100:103], v[92:95]
    s_waitcnt vmcnt(4)
    s_barrier
    ds_read_b128 v[104:107], v120 offset:18432
    ds_read_b128 v[108:111], v120 offset:20736
    ds_read_b128 v[112:115], v120 offset:18448
    ds_read_b128 v[116:119], v120 offset:20752
    ds_read_b128 v[96:99], v120 offset:18464
    ds_read_b128 v[100:103], v120 offset:20768
    s_waitcnt lgkmcnt(5)
    v_mfma_f32_16x16x32_bf16 v[88:91], v[32:35], v[104:107], v[88:91]
    s_waitcnt lgkmcnt(4)
    v_mfma_f32_16x16x32_bf16 v[92:95], v[32:35], v[108:111], v[92:95]
    ds_read_b128 v[104:107], v120 offset:18480
    ds_read_b128 v[108:111], v120 offset:20784
    s_waitcnt lgkmcnt(5)
    v_mfma_f32_16x16x32_bf16 v[88:91], v[36:39], v[112:115], v[88:91]
    s_waitcnt lgkmcnt(4)
    v_mfma_f32_16x16x32_bf16 v[92:95], v[36:39], v[116:119], v[92:95]
    s_waitcnt lgkmcnt(3)
    v_mfma_f32_16x16x32_bf16 v[88:91], v[40:43], v[96:99], v[88:91]
    s_waitcnt lgkmcnt(2)
    v_mfma_f32_16x16x32_bf16 v[92:95], v[40:43], v[100:103], v[92:95]
    s_waitcnt lgkmcnt(1)
    v_mfma_f32_16x16x32_bf16 v[88:91], v[44:47], v[104:107], v[88:91]
    s_waitcnt lgkmcnt(0)
    v_mfma_f32_16x16x32_bf16 v[92:95], v[44:47], v[108:111], v[92:95]
    s_waitcnt vmcnt(2)
    s_barrier
    ds_read_b128 v[112:115], v120 offset:36864
    ds_read_b128 v[116:119], v120 offset:39168
    ds_read_b128 v[96:99], v120 offset:36880
    ds_read_b128 v[100:103], v120 offset:39184
    ds_read_b128 v[104:107], v120 offset:36896
    ds_read_b128 v[108:111], v120 offset:39200
    s_waitcnt lgkmcnt(5)
    v_mfma_f32_16x16x32_bf16 v[88:91], v[48:51], v[112:115], v[88:91]
    s_waitcnt lgkmcnt(4)
    v_mfma_f32_16x16x32_bf16 v[92:95], v[48:51], v[116:119], v[92:95]
    ds_read_b128 v[112:115], v120 offset:36912
    ds_read_b128 v[116:119], v120 offset:39216
    s_waitcnt lgkmcnt(5)
    v_mfma_f32_16x16x32_bf16 v[88:91], v[52:55], v[96:99], v[88:91]
    s_waitcnt lgkmcnt(4)
    v_mfma_f32_16x16x32_bf16 v[92:95], v[52:55], v[100:103], v[92:95]
    s_waitcnt lgkmcnt(3)
    v_mfma_f32_16x16x32_bf16 v[88:91], v[56:59], v[104:107], v[88:91]
    s_waitcnt lgkmcnt(2)
    v_mfma_f32_16x16x32_bf16 v[92:95], v[56:59], v[108:111], v[92:95]
    s_waitcnt lgkmcnt(1)
    v_mfma_f32_16x16x32_bf16 v[88:91], v[60:63], v[112:115], v[88:91]
    s_waitcnt lgkmcnt(0)
    v_mfma_f32_16x16x32_bf16 v[92:95], v[60:63], v[116:119], v[92:95]
    s_waitcnt vmcnt(0)
    s_barrier
    ds_read_b128 v[96:99], v120 offset:55296
    ds_read_b128 v[100:103], v120 offset:57600
    ds_read_b128 v[104:107], v120 offset:55312
    ds_read_b128 v[108:111], v120 offset:57616
    ds_read_b128 v[112:115], v120 offset:55328
    ds_read_b128 v[116:119], v120 offset:57632
    s_waitcnt lgkmcnt(5)
    v_mfma_f32_16x16x32_bf16 v[88:91], v[64:67], v[96:99], v[88:91]
    s_waitcnt lgkmcnt(4)
    v_mfma_f32_16x16x32_bf16 v[92:95], v[64:67], v[100:103], v[92:95]
    ds_read_b128 v[96:99], v120 offset:55344
    ds_read_b128 v[100:103], v120 offset:57648
    s_waitcnt lgkmcnt(5)
    v_mfma_f32_16x16x32_bf16 v[88:91], v[68:71], v[104:107], v[88:91]
    s_waitcnt lgkmcnt(4)
    v_mfma_f32_16x16x32_bf16 v[92:95], v[68:71], v[108:111], v[92:95]
    ds_read_b128 v[104:107], v121 offset:128
    ds_read_b128 v[108:111], v121 offset:2432
    s_waitcnt lgkmcnt(5)
    v_mfma_f32_16x16x32_bf16 v[88:91], v[72:75], v[112:115], v[88:91]
    s_waitcnt lgkmcnt(4)
    v_mfma_f32_16x16x32_bf16 v[92:95], v[72:75], v[116:119], v[92:95]
    ds_read_b128 v[112:115], v121 offset:36992
    ds_read_b128 v[116:119], v121 offset:39296
    s_waitcnt lgkmcnt(5)
    v_mfma_f32_16x16x32_bf16 v[88:91], v[76:79], v[96:99], v[88:91]
    s_waitcnt lgkmcnt(4)
    v_mfma_f32_16x16x32_bf16 v[92:95], v[76:79], v[100:103], v[92:95]
    s_waitcnt lgkmcnt(3)
    v_mfma_f32_16x16x32_bf16 v[88:91], v[80:83], v[104:107], v[88:91]
    s_waitcnt lgkmcnt(2)
    v_mfma_f32_16x16x32_bf16 v[92:95], v[80:83], v[108:111], v[92:95]
    s_waitcnt lgkmcnt(1)
    v_mfma_f32_16x16x32_bf16 v[88:91], v[84:87], v[112:115], v[88:91]
    s_waitcnt lgkmcnt(0)
    v_mfma_f32_16x16x32_bf16 v[92:95], v[84:87], v[116:119], v[92:95]
    s_nop 7
    v_cvt_pk_bf16_f32 v88, v88, v89
    v_cvt_pk_bf16_f32 v89, v90, v91
    v_cvt_pk_bf16_f32 v92, v92, v93
    v_cvt_pk_bf16_f32 v93, v94, v95
    buffer_store_dwordx2 v[88:89], v123, s[32:35], s14 offen
    buffer_store_dwordx2 v[92:93], v123, s[32:35], s15 offen
    s_branch L_o_end
L_o_half:
    s_cmp_lg_u32 s4, 11
    s_cbranch_scc1 L_o_h2
    s_lshl_b32 s10, s5, 11
    s_add_u32 s10, s10, 8257536
    v_and_b32 v104, 15, v1
    v_lshlrev_b32 v104, 7, v104
    v_add_u32 v124, s10, v104
    s_cmp_lt_u32 s7, 4
    s_cselect_b32 s16, 7, 3
    s_setprio 0
W_21:
    ds_read_b32 v4, v2 offset:100
    s_waitcnt lgkmcnt(0)
    v_readfirstlane_b32 s3, v4
    s_cmp_ge_u32 s3, 2
    s_cbranch_scc1 WD_22
    s_sub_u32 s8, s8, 1
    s_cselect_b32 s8, 0, s8
    s_cbranch_scc1 WD_22
    s_sleep 2
    s_branch W_21
WD_22:
    s_setprio 3
    buffer_load_dword v125, v124, s[20:23], 0 offen sc1
P_23:
    s_sleep 1
    buffer_load_dword v126, v124, s[20:23], 0 offen sc1
    s_waitcnt vmcnt(1)
    v_cmp_ne_u32 vcc, s9, v125
    s_cbranch_vccz PD_24
    s_sleep 1
    buffer_load_dword v125, v124, s[20:23], 0 offen sc1
    s_waitcnt vmcnt(1)
    v_cmp_ne_u32 vcc, s9, v126
    s_cbranch_vccz PD_24
    s_sub_u32 s8, s8, 16
    s_cselect_b32 s8, 0, s8
    s_cbranch_scc1 PD_24
    s_branch P_23
PD_24:
W_25:
    ds_read_b32 v4, v2 offset:60
    s_waitcnt lgkmcnt(0)
    v_readfirstlane_b32 s3, v4
    s_cmp_ge_u32 s3, s16
    s_cbranch_scc1 WD_26
    s_sub_u32 s8, s8, 1
    s_cselect_b32 s8, 0, s8
    s_cbranch_scc1 WD_26
    s_sleep 0
    s_branch W_25
WD_26:
    ds_write_b32 v2, v3 offset:104
L_o_h2:
    s_barrier
    ds_read_b128 v[96:99], v120 offset:0
    ds_read_b128 v[104:107], v120 offset:16
    ds_read_b128 v[112:115], v120 offset:32
    s_waitcnt lgkmcnt(2)
    v_mfma_f32_16x16x32_bf16 v[88:91], v[16:19], v[96:99], 0
    ds_read_b128 v[96:99], v120 offset:48
    s_waitcnt lgkmcnt(2)
    v_mfma_f32_16x16x32_bf16 v[88:91], v[20:23], v[104:107], v[88:91]
    s_waitcnt lgkmcnt(1)
    v_mfma_f32_16x16x32_bf16 v[88:91], v[24:27], v[112:115], v[88:91]
    s_waitcnt lgkmcnt(0)
    v_mfma_f32_16x16x32_bf16 v[88:91], v[28:31], v[96:99], v[88:91]
    s_barrier
    ds_read_b128 v[104:107], v120 offset:18432
    ds_read_b128 v[112:115], v120 offset:18448
    ds_read_b128 v[96:99], v120 offset:18464
    s_waitcnt lgkmcnt(2)
    v_mfma_f32_16x16x32_bf16 v[88:91], v[32:35], v[104:107], v[88:91]
    ds_read_b128 v[104:107], v120 offset:18480
    s_waitcnt lgkmcnt(2)
    v_mfma_f32_16x16x32_bf16 v[88:91], v[36:39], v[112:115], v[88:91]
    s_waitcnt lgkmcnt(1)
    v_mfma_f32_16x16x32_bf16 v[88:91], v[40:43], v[96:99], v[88:91]
    s_waitcnt lgkmcnt(0)
    v_mfma_f32_16x16x32_bf16 v[88:91], v[44:47], v[104:107], v[88:91]
    s_barrier
    ds_read_b128 v[112:115], v120 offset:36864
    ds_read_b128 v[96:99], v120 offset:36880
    ds_read_b128 v[104:107], v120 offset:36896
    s_waitcnt lgkmcnt(2)
    v_mfma_f32_16x16x32_bf16 v[88:91], v[48:51], v[112:115], v[88:91]
    ds_read_b128 v[112:115], v120 offset:36912
    s_waitcnt lgkmcnt(2)
    v_mfma_f32_16x16x32_bf16 v[88:91], v[52:55], v[96:99], v[88:91]
    s_waitcnt lgkmcnt(1)
    v_mfma_f32_16x16x32_bf16 v[88:91], v[56:59], v[104:107], v[88:91]
    s_waitcnt lgkmcnt(0)
    v_mfma_f32_16x16x32_bf16 v[88:91], v[60:63], v[112:115], v[88:91]
    s_barrier
    ds_read_b128 v[96:99], v120 offset:55296
    ds_read_b128 v[104:107], v120 offset:55312
    ds_read_b128 v[112:115], v120 offset:55328
    s_waitcnt lgkmcnt(2)
    v_mfma_f32_16x16x32_bf16 v[88:91], v[64:67], v[96:99], v[88:91]
    ds_read_b128 v[96:99], v120 offset:55344
    s_waitcnt lgkmcnt(2)
    v_mfma_f32_16x16x32_bf16 v[88:91], v[68:71], v[104:107], v[88:91]
    ds_read_b128 v[104:107], v121 offset:128
    s_waitcnt lgkmcnt(2)
    v_mfma_f32_16x16x32_bf16 v[88:91], v[72:75], v[112:115], v[88:91]
    ds_read_b128 v[112:115], v121 offset:36992
    s_waitcnt lgkmcnt(2)
    v_mfma_f32_16x16x32_bf16 v[88:91], v[76:79], v[96:99], v[88:91]
    s_waitcnt lgkmcnt(1)
    v_mfma_f32_16x16x32_bf16 v[88:91], v[80:83], v[104:107], v[88:91]
    s_waitcnt lgkmcnt(0)
    v_mfma_f32_16x16x32_bf16 v[88:91], v[84:87], v[112:115], v[88:91]
    s_nop 7
    v_cvt_pk_bf16_f32 v88, v88, v89
    v_cvt_pk_bf16_f32 v89, v90, v91
    s_mov_b32 exec_hi, 0
    buffer_store_dwordx2 v[88:89], v123, s[32:35], s14 offen
L_o_end:
    s_endpgm
QS_7:
W_27:
    ds_read_b32 v4, v2 offset:20
    s_waitcnt lgkmcnt(0)
    v_readfirstlane_b32 s3, v4
    s_cmp_ge_u32 s3, 2
    s_cbranch_scc1 WD_28
    s_sub_u32 s8, s8, 1
    s_cselect_b32 s8, 0, s8
    s_cbranch_scc1 WD_28
    s_sleep 0
    s_branch W_27
WD_28:
    s_branch QB_8
QS_9:
W_29:
    ds_read_b32 v4, v2 offset:20
    s_waitcnt lgkmcnt(0)
    v_readfirstlane_b32 s3, v4
    s_cmp_ge_u32 s3, 3
    s_cbranch_scc1 WD_30
    s_sub_u32 s8, s8, 1
    s_cselect_b32 s8, 0, s8
    s_cbranch_scc1 WD_30
    s_sleep 0
    s_branch W_29
WD_30:
    s_branch QB_10
L_o_slow:
W_31:
    ds_read_b32 v4, v2 offset:72
    s_waitcnt lgkmcnt(0)
    v_readfirstlane_b32 s3, v4
    s_cmp_ge_u32 s3, 1
    s_cbranch_scc1 WD_32
    s_sub_u32 s8, s8, 1
    s_cselect_b32 s8, 0, s8
    s_cbranch_scc1 WD_32
    s_sleep 1
    s_branch W_31
WD_32:
    s_branch L_o_back
L_att_slow1:
W_33:
    ds_read_b32 v4, v2 offset:40
    s_waitcnt lgkmcnt(0)
    v_readfirstlane_b32 s3, v4
    s_cmp_ge_u32 s3, s78
    s_cbranch_scc1 WD_34
    s_sub_u32 s8, s8, 1
    s_cselect_b32 s8, 0, s8
    s_cbranch_scc1 WD_34
    s_sleep 1
    s_branch W_33
WD_34:
    s_branch L_att_back1
L_att_slow5:
W_35:
    ds_read_b32 v4, v2 offset:40
    s_waitcnt lgkmcnt(0)
    v_readfirstlane_b32 s3, v4
    s_cmp_ge_u32 s3, s78
    s_cbranch_scc1 WD_36
    s_sub_u32 s8, s8, 1
    s_cselect_b32 s8, 0, s8
    s_cbranch_scc1 WD_36
    s_sleep 1
    s_branch W_35
WD_36:
    s_branch L_att_back5
L_maxpass:
    s_nop 7
    v_mov_b32 v48, 0xff800000
    s_mov_b32 s77, 0
L_mx_chunk:
    s_add_u32 s10, s74, 2
W_37:
    ds_read_b32 v4, v2 offset:40
    s_waitcnt lgkmcnt(0)
    v_readfirstlane_b32 s3, v4
    s_cmp_ge_u32 s3, s10
    s_cbranch_scc1 WD_38
    s_sub_u32 s8, s8, 1
    s_cselect_b32 s8, 0, s8
    s_cbranch_scc1 WD_38
    s_sleep 1
    s_branch W_37
WD_38:
    s_mov_b32 s78, 4
    v_mov_b32 v104, v96
    v_mov_b32 v105, v97
L_mx_pair:
    ds_read_b128 v[80:83], v104
    ds_read_b128 v[84:87], v105 offset:4608
    ds_read_b128 v[88:91], v104 offset:1024
    s_waitcnt lgkmcnt(0)
    v_mfma_f32_32x32x8_bf16 v[16:31], v[84:85], v[76:77], 0
    v_mfma_f32_32x32x16_bf16 v[16:31], v[80:83], v[72:75], v[16:31]
    v_mfma_f32_32x32x8_bf16 v[32:47], v[86:87], v[76:77], 0
    v_mfma_f32_32x32x16_bf16 v[32:47], v[88:91], v[72:75], v[32:47]
    v_add_u32 v104, 5120, v104
    v_add_u32 v105, 5120, v105
    s_nop 11
    v_max3_f32 v48, v16, v17, v48
    v_max3_f32 v48, v18, v19, v48
    v_max3_f32 v48, v20, v21, v48
    v_max3_f32 v48, v22, v23, v48
    v_max3_f32 v48, v24, v25, v48
    v_max3_f32 v48, v26, v27, v48
    v_max3_f32 v48, v28, v29, v48
    v_max3_f32 v48, v30, v31, v48
    v_max3_f32 v48, v32, v33, v48
    v_max3_f32 v48, v34, v35, v48
    v_max3_f32 v48, v36, v37, v48
    v_max3_f32 v48, v38, v39, v48
    v_max3_f32 v48, v40, v41, v48
    v_max3_f32 v48, v42, v43, v48
    v_max3_f32 v48, v44, v45, v48
    v_max3_f32 v48, v46, v47, v48
    s_sub_u32 s78, s78, 1
    s_cmp_lg_u32 s78, 0
    s_cbranch_scc1 L_mx_pair
    s_sub_u32 s75, s75, 1
    s_mov_b32 s76, 0xffffb000
    s_cselect_b32 s76, 40960, s76
    s_cselect_b32 s75, 2, s75
    v_add_u32 v96, s76, v96
    v_add_u32 v97, s76, v97
    v_add_u32 v98, s76, v98
    s_add_u32 s74, s74, 2
    v_mov_b32 v99, s74
    s_mov_b64 exec, 1
    ds_write_b32 v100, v99
    s_mov_b64 exec, -1
    s_add_u32 s77, s77, 1
    s_cmp_lt_u32 s77, 8
    s_cbranch_scc1 L_mx_chunk
    v_mov_b32 v105, v48
    s_nop 1
    v_permlane32_swap_b32 v48, v105
    s_nop 1
    v_max_f32 v104, v48, v105
    v_sub_f32 v104, 0, v104
    v_and_b32 v105, 0xffff0000, v104
    v_sub_f32 v104, v104, v105
    v_and_b32 v106, 0xffff0000, v104
    v_sub_f32 v104, v104, v106
    v_lshrrev_b32 v105, 16, v105
    v_or_b32 v105, v105, v106
    v_lshrrev_b32 v104, 16, v104
    v_cmp_gt_u32 vcc, 32, v1
    s_nop 1
    v_cndmask_b32 v77, v104, v105, vcc
    s_mov_b32 s79, 1
    s_branch L_pass
L_b_rest:
    s_and_b32 s73, s72, 1
    s_lshr_b32 s74, s72, 1
    s_and_b32 s75, s7, 1
    v_lshrrev_b32 v5, 4, v1
    v_bfe_u32 v6, v1, 2, 2
    v_lshl_add_u32 v6, v5, 3, v6
    v_mul_u32_u24 v6, 48, v6
    v_and_b32 v7, 3, v1
    s_cmp_eq_u32 s73, 0
    s_cselect_b32 s10, 3, 0
    s_mov_b32 s11, 129056
    s_cselect_b32 s11, 129024, s11
    v_and_b32 v7, s10, v7
    v_lshl_add_u32 v12, v7, 3, v6
    v_add_u32 v12, s11, v12
    s_lshl_b32 s10, s75, 5
    s_lshl_b32 s11, s74, 4
    s_add_u32 s10, s10, s11
    v_and_b32 v6, 15, v1
    v_add_u32 v6, s10, v6
    v_lshrrev_b32 v7, 3, v6
    v_mul_u32_u24 v7, 9216, v7
    v_and_b32 v8, 7, v6
    v_lshl_add_u32 v7, v8, 7, v7
    v_bfe_u32 v8, v6, 1, 3
    v_xor_b32 v8, v8, v5
    v_lshl_add_u32 v13, v8, 4, v7
    v_xor_b32 v6, 4, v8
    v_lshl_add_u32 v14, v6, 4, v7
    v_mov_b32 v64, 0
    v_mov_b32 v65, 0
    v_mov_b32 v66, 0
    v_mov_b32 v67, 0
    s_mul_i32 s12, s5, 5120
    s_mov_b64 s[14:15], -1
    s_mov_b64 s[16:17], -1
    v_and_b32 v7, 15, v1
    s_cmp_ge_u32 s7, 2
    s_cbranch_scc1 L_b_vadr
    s_lshl_b32 s10, s74, 4
    v_add_u32 v15, s10, v7
    v_lshlrev_b32 v15, 4, v15
    s_mov_b64 s[16:17], 0xffff
    s_cmp_lg_u32 s73, 0
    s_cbranch_scc1 L_b_k1adr
    v_lshrrev_b32 v8, 5, v1
    v_lshl_add_u32 v15, v8, 9, v15
    v_bfe_u32 v8, v1, 4, 1
    v_lshl_add_u32 v15, v8, 3, v15
    s_lshl_b32 s10, s75, 10
    s_add_u32 s12, s12, s10
    s_branch L_b_adr
L_b_k1adr:
    s_lshl_b32 s10, s75, 3
    s_add_u32 s12, s12, s10
    s_add_u32 s12, s12, 4608
    s_mov_b64 s[14:15], 0xffff
    s_branch L_b_adr
L_b_vadr:
    v_and_b32 v8, 3, v7
    v_bfe_u32 v9, v7, 2, 1
    v_lshl_add_u32 v8, v9, 3, v8
    v_bfe_u32 v9, v7, 3, 1
    v_lshl_add_u32 v8, v9, 2, v8
    s_cmp_eq_u32 s73, 0
    s_cbranch_scc1 L_b_v0
    v_add_u32 v8, 16, v7
    v_cmp_gt_u32 s[14:15], 4, v7
    v_cmp_gt_u32 s[16:17], 2, v7
L_b_v0:
    v_bfe_u32 v9, v1, 4, 1
    v_mul_u32_u24 v9, 20, v9
    v_add_u32 v8, v8, v9
    v_lshlrev_b32 v8, 4, v8
    v_lshrrev_b32 v9, 5, v1
    v_lshl_add_u32 v15, v9, 3, v8
    s_mul_i32 s10, s75, 1280
    s_mul_i32 s11, s74, 640
    s_add_u32 s10, s10, s11
    s_add_u32 s12, s12, s10
    s_add_u32 s12, s12, 2048
L_b_adr:
    s_lshl_b32 s18, s5, 2
    s_add_u32 s18, s18, s7
    s_lshl_b32 s18, s18, 7
    s_add_u32 s18, s18, 7340032
    s_waitcnt vmcnt(0)
    s_mov_b64 exec, 1
    ds_add_u32 v2, v3 offset:16
    s_mov_b64 exec, -1
W_39:
    ds_read_b32 v4, v2 offset:16
    s_waitcnt lgkmcnt(0)
    v_readfirstlane_b32 s3, v4
    s_cmp_ge_u32 s3, 4
    s_cbranch_scc1 WD_40
    s_sub_u32 s8, s8, 1
    s_cselect_b32 s8, 0, s8
    s_cbranch_scc1 WD_40
    s_sleep 0
    s_branch W_39
WD_40:
    s_cmp_ge_u32 s7, 2
    s_cbranch_scc1 L_b_vjob
W_41:
    ds_read_b32 v4, v2 offset:0
    s_waitcnt lgkmcnt(0)
    v_readfirstlane_b32 s3, v4
    s_cmp_ge_u32 s3, 4
    s_cbranch_scc1 WD_42
    s_sub_u32 s8, s8, 1
    s_cselect_b32 s8, 0, s8
    s_cbranch_scc1 WD_42
    s_sleep 0
    s_branch W_41
WD_42:
    ds_read_b64_tr_b16 v[16:17], v12 offset:0
    ds_read_b64_tr_b16 v[18:19], v12 offset:192
    ds_read_b128 v[20:23], v13 offset:0
    ds_read_b64_tr_b16 v[24:25], v12 offset:1536
    ds_read_b64_tr_b16 v[26:27], v12 offset:1728
    ds_read_b128 v[28:31], v14 offset:0
    ds_read_b64_tr_b16 v[32:33], v12 offset:3072
    ds_read_b64_tr_b16 v[34:35], v12 offset:3264
    ds_read_b128 v[36:39], v13 offset:1024
    ds_read_b64_tr_b16 v[40:41], v12 offset:4608
    ds_read_b64_tr_b16 v[42:43], v12 offset:4800
    ds_read_b128 v[44:47], v14 offset:1024
    ds_read_b64_tr_b16 v[48:49], v12 offset:6144
    ds_read_b64_tr_b16 v[50:51], v12 offset:6336
    ds_read_b128 v[52:55], v13 offset:2048
    s_waitcnt lgkmcnt(12)
    v_mfma_f32_16x16x32_bf16 v[64:67], v[16:19], v[20:23], v[64:67]
    ds_read_b64_tr_b16 v[56:57], v12 offset:7680
    ds_read_b64_tr_b16 v[58:59], v12 offset:7872
    ds_read_b128 v[60:63], v14 offset:2048
    s_waitcnt lgkmcnt(12)
    v_mfma_f32_16x16x32_bf16 v[64:67], v[24:27], v[28:31], v[64:67]
    s_waitcnt lgkmcnt(9)
    v_mfma_f32_16x16x32_bf16 v[64:67], v[32:35], v[36:39], v[64:67]
    s_waitcnt lgkmcnt(6)
    v_mfma_f32_16x16x32_bf16 v[64:67], v[40:43], v[44:47], v[64:67]
    s_waitcnt lgkmcnt(3)
    v_mfma_f32_16x16x32_bf16 v[64:67], v[48:51], v[52:55], v[64:67]
    s_waitcnt lgkmcnt(0)
    v_mfma_f32_16x16x32_bf16 v[64:67], v[56:59], v[60:63], v[64:67]
W_43:
    ds_read_b32 v4, v2 offset:4
    s_waitcnt lgkmcnt(0)
    v_readfirstlane_b32 s3, v4
    s_cmp_ge_u32 s3, 4
    s_cbranch_scc1 WD_44
    s_sub_u32 s8, s8, 1
    s_cselect_b32 s8, 0, s8
    s_cbranch_scc1 WD_44
    s_sleep 0
    s_branch W_43
WD_44:
    ds_read_b64_tr_b16 v[16:17], v12 offset:9216
    ds_read_b64_tr_b16 v[18:19], v12 offset:9408
    ds_read_b128 v[20:23], v13 offset:3072
    ds_read_b64_tr_b16 v[24:25], v12 offset:10752
    ds_read_b64_tr_b16 v[26:27], v12 offset:10944
    ds_read_b128 v[28:31], v14 offset:3072
    ds_read_b64_tr_b16 v[32:33], v12 offset:12288
    ds_read_b64_tr_b16 v[34:35], v12 offset:12480
    ds_read_b128 v[36:39], v13 offset:4096
    ds_read_b64_tr_b16 v[40:41], v12 offset:13824
    ds_read_b64_tr_b16 v[42:43], v12 offset:14016
    ds_read_b128 v[44:47], v14 offset:4096
    ds_read_b64_tr_b16 v[48:49], v12 offset:15360
    ds_read_b64_tr_b16 v[50:51], v12 offset:15552
    ds_read_b128 v[52:55], v13 offset:5120
    s_waitcnt lgkmcnt(12)
    v_mfma_f32_16x16x32_bf16 v[64:67], v[16:19], v[20:23], v[64:67]
    ds_read_b64_tr_b16 v[56:57], v12 offset:16896
    ds_read_b64_tr_b16 v[58:59], v12 offset:17088
    ds_read_b128 v[60:63], v14 offset:5120
    s_waitcnt lgkmcnt(12)
    v_mfma_f32_16x16x32_bf16 v[64:67], v[24:27], v[28:31], v[64:67]
    s_waitcnt lgkmcnt(9)
    v_mfma_f32_16x16x32_bf16 v[64:67], v[32:35], v[36:39], v[64:67]
    s_waitcnt lgkmcnt(6)
    v_mfma_f32_16x16x32_bf16 v[64:67], v[40:43], v[44:47], v[64:67]
    s_waitcnt lgkmcnt(3)
    v_mfma_f32_16x16x32_bf16 v[64:67], v[48:51], v[52:55], v[64:67]
    s_waitcnt lgkmcnt(0)
    v_mfma_f32_16x16x32_bf16 v[64:67], v[56:59], v[60:63], v[64:67]
W_45:
    ds_read_b32 v4, v2 offset:8
    s_waitcnt lgkmcnt(0)
    v_readfirstlane_b32 s3, v4
    s_cmp_ge_u32 s3, 4
    s_cbranch_scc1 WD_46
    s_sub_u32 s8, s8, 1
    s_cselect_b32 s8, 0, s8
    s_cbranch_scc1 WD_46
    s_sleep 0
    s_branch W_45
WD_46:
    ds_read_b64_tr_b16 v[16:17], v12 offset:18432
    ds_read_b64_tr_b16 v[18:19], v12 offset:18624
    ds_read_b128 v[20:23], v13 offset:6144
    ds_read_b64_tr_b16 v[24:25], v12 offset:19968
    ds_read_b64_tr_b16 v[26:27], v12 offset:20160
    ds_read_b128 v[28:31], v14 offset:6144
    ds_read_b64_tr_b16 v[32:33], v12 offset:21504
    ds_read_b64_tr_b16 v[34:35], v12 offset:21696
    ds_read_b128 v[36:39], v13 offset:7168
    ds_read_b64_tr_b16 v[40:41], v12 offset:23040
    ds_read_b64_tr_b16 v[42:43], v12 offset:23232
    ds_read_b128 v[44:47], v14 offset:7168
    ds_read_b64_tr_b16 v[48:49], v12 offset:24576
    ds_read_b64_tr_b16 v[50:51], v12 offset:24768
    ds_read_b128 v[52:55], v13 offset:8192
    s_waitcnt lgkmcnt(12)
    v_mfma_f32_16x16x32_bf16 v[64:67], v[16:19], v[20:23], v[64:67]
    ds_read_b64_tr_b16 v[56:57], v12 offset:26112
    ds_read_b64_tr_b16 v[58:59], v12 offset:26304
    ds_read_b128 v[60:63], v14 offset:8192
    s_waitcnt lgkmcnt(12)
    v_mfma_f32_16x16x32_bf16 v[64:67], v[24:27], v[28:31], v[64:67]
    s_waitcnt lgkmcnt(9)
    v_mfma_f32_16x16x32_bf16 v[64:67], v[32:35], v[36:39], v[64:67]
    s_waitcnt lgkmcnt(6)
    v_mfma_f32_16x16x32_bf16 v[64:67], v[40:43], v[44:47], v[64:67]
    s_waitcnt lgkmcnt(3)
    v_mfma_f32_16x16x32_bf16 v[64:67], v[48:51], v[52:55], v[64:67]
    s_waitcnt lgkmcnt(0)
    v_mfma_f32_16x16x32_bf16 v[64:67], v[56:59], v[60:63], v[64:67]
    s_nop 7
    v_cvt_pk_bf16_f32 v68, v64, v65
    v_cvt_pk_bf16_f32 v69, v66, v67
    s_cmp_lg_u32 s73, 0
    s_cbranch_scc1 L_b_k1
    s_mov_b64 exec, s[14:15]
    buffer_store_dwordx2 v[68:69], v15, s[20:23], s12 offen sc1
    s_mov_b64 exec, -1
    v_mul_f32 v6, v64, v64
    v_fmac_f32 v6, v65, v65
    v_fmac_f32 v6, v66, v66
    v_fmac_f32 v6, v67, v67
    v_mov_b32 v8, v6
    s_nop 1
    v_permlane16_swap_b32 v6, v8
    s_nop 1
    v_add_f32 v6, v6, v8
    v_mov_b32 v8, v6
    s_nop 1
    v_permlane32_swap_b32 v6, v8
    s_nop 1
    v_add_f32 v6, v6, v8
    s_mov_b64 exec, s[16:17]
    ds_max_u32 v2, v6 offset:52
    s_mov_b64 exec, -1
    s_branch L_b_jpub
L_b_k1:
    v_mov_b32 v69, 0x3f803f80
    s_mov_b64 exec, s[14:15]
    buffer_store_dwordx2 v[68:69], v15, s[20:23], s12 offen sc1
    s_mov_b64 exec, -1
    v_mul_f32 v6, v64, v64
    v_fmac_f32 v6, v65, v65
    s_mov_b64 exec, s[16:17]
    ds_max_u32 v2, v6 offset:56
    s_mov_b64 exec, -1
    s_branch L_b_jpub
L_b_vjob:
W_47:
    ds_read_b32 v4, v2 offset:0
    s_waitcnt lgkmcnt(0)
    v_readfirstlane_b32 s3, v4
    s_cmp_ge_u32 s3, 4
    s_cbranch_scc1 WD_48
    s_sub_u32 s8, s8, 1
    s_cselect_b32 s8, 0, s8
    s_cbranch_scc1 WD_48
    s_sleep 0
    s_branch W_47
WD_48:
    ds_read_b64_tr_b16 v[16:17], v12 offset:0
    ds_read_b64_tr_b16 v[18:19], v12 offset:192
    ds_read_b128 v[20:23], v13 offset:0
    ds_read_b64_tr_b16 v[24:25], v12 offset:1536
    ds_read_b64_tr_b16 v[26:27], v12 offset:1728
    ds_read_b128 v[28:31], v14 offset:0
    ds_read_b64_tr_b16 v[32:33], v12 offset:3072
    ds_read_b64_tr_b16 v[34:35], v12 offset:3264
    ds_read_b128 v[36:39], v13 offset:1024
    ds_read_b64_tr_b16 v[40:41], v12 offset:4608
    ds_read_b64_tr_b16 v[42:43], v12 offset:4800
    ds_read_b128 v[44:47], v14 offset:1024
    ds_read_b64_tr_b16 v[48:49], v12 offset:6144
    ds_read_b64_tr_b16 v[50:51], v12 offset:6336
    ds_read_b128 v[52:55], v13 offset:2048
    s_waitcnt lgkmcnt(12)
    v_mfma_f32_16x16x32_bf16 v[64:67], v[20:23], v[16:19], v[64:67]
    ds_read_b64_tr_b16 v[56:57], v12 offset:7680
    ds_read_b64_tr_b16 v[58:59], v12 offset:7872
    ds_read_b128 v[60:63], v14 offset:2048
    s_waitcnt lgkmcnt(12)
    v_mfma_f32_16x16x32_bf16 v[64:67], v[28:31], v[24:27], v[64:67]
    s_waitcnt lgkmcnt(9)
    v_mfma_f32_16x16x32_bf16 v[64:67], v[36:39], v[32:35], v[64:67]
    s_waitcnt lgkmcnt(6)
    v_mfma_f32_16x16x32_bf16 v[64:67], v[44:47], v[40:43], v[64:67]
    s_waitcnt lgkmcnt(3)
    v_mfma_f32_16x16x32_bf16 v[64:67], v[52:55], v[48:51], v[64:67]
    s_waitcnt lgkmcnt(0)
    v_mfma_f32_16x16x32_bf16 v[64:67], v[60:63], v[56:59], v[64:67]
W_49:
    ds_read_b32 v4, v2 offset:4
    s_waitcnt lgkmcnt(0)
    v_readfirstlane_b32 s3, v4
    s_cmp_ge_u32 s3, 4
    s_cbranch_scc1 WD_50
    s_sub_u32 s8, s8, 1
    s_cselect_b32 s8, 0, s8
    s_cbranch_scc1 WD_50
    s_sleep 0
    s_branch W_49
WD_50:
    ds_read_b64_tr_b16 v[16:17], v12 offset:9216
    ds_read_b64_tr_b16 v[18:19], v12 offset:9408
    ds_read_b128 v[20:23], v13 offset:3072
    ds_read_b64_tr_b16 v[24:25], v12 offset:10752
    ds_read_b64_tr_b16 v[26:27], v12 offset:10944
    ds_read_b128 v[28:31], v14 offset:3072
    ds_read_b64_tr_b16 v[32:33], v12 offset:12288
    ds_read_b64_tr_b16 v[34:35], v12 offset:12480
    ds_read_b128 v[36:39], v13 offset:4096
    ds_read_b64_tr_b16 v[40:41], v12 offset:13824
    ds_read_b64_tr_b16 v[42:43], v12 offset:14016
    ds_read_b128 v[44:47], v14 offset:4096
    ds_read_b64_tr_b16 v[48:49], v12 offset:15360
    ds_read_b64_tr_b16 v[50:51], v12 offset:15552
    ds_read_b128 v[52:55], v13 offset:5120
    s_waitcnt lgkmcnt(12)
    v_mfma_f32_16x16x32_bf16 v[64:67], v[20:23], v[16:19], v[64:67]
    ds_read_b64_tr_b16 v[56:57], v12 offset:16896
    ds_read_b64_tr_b16 v[58:59], v12 offset:17088
    ds_read_b128 v[60:63], v14 offset:5120
    s_waitcnt lgkmcnt(12)
    v_mfma_f32_16x16x32_bf16 v[64:67], v[28:31], v[24:27], v[64:67]
    s_waitcnt lgkmcnt(9)
    v_mfma_f32_16x16x32_bf16 v[64:67], v[36:39], v[32:35], v[64:67]
    s_waitcnt lgkmcnt(6)
    v_mfma_f32_16x16x32_bf16 v[64:67], v[44:47], v[40:43], v[64:67]
    s_waitcnt lgkmcnt(3)
    v_mfma_f32_16x16x32_bf16 v[64:67], v[52:55], v[48:51], v[64:67]
    s_waitcnt lgkmcnt(0)
    v_mfma_f32_16x16x32_bf16 v[64:67], v[60:63], v[56:59], v[64:67]
W_51:
    ds_read_b32 v4, v2 offset:8
    s_waitcnt lgkmcnt(0)
    v_readfirstlane_b32 s3, v4
    s_cmp_ge_u32 s3, 4
    s_cbranch_scc1 WD_52
    s_sub_u32 s8, s8, 1
    s_cselect_b32 s8, 0, s8
    s_cbranch_scc1 WD_52
    s_sleep 0
    s_branch W_51
WD_52:
    ds_read_b64_tr_b16 v[16:17], v12 offset:18432
    ds_read_b64_tr_b16 v[18:19], v12 offset:18624
    ds_read_b128 v[20:23], v13 offset:6144
    ds_read_b64_tr_b16 v[24:25], v12 offset:19968
    ds_read_b64_tr_b16 v[26:27], v12 offset:20160
    ds_read_b128 v[28:31], v14 offset:6144
    ds_read_b64_tr_b16 v[32:33], v12 offset:21504
    ds_read_b64_tr_b16 v[34:35], v12 offset:21696
    ds_read_b128 v[36:39], v13 offset:7168
    ds_read_b64_tr_b16 v[40:41], v12 offset:23040
    ds_read_b64_tr_b16 v[42:43], v12 offset:23232
    ds_read_b128 v[44:47], v14 offset:7168
    ds_read_b64_tr_b16 v[48:49], v12 offset:24576
    ds_read_b64_tr_b16 v[50:51], v12 offset:24768
    ds_read_b128 v[52:55], v13 offset:8192
    s_waitcnt lgkmcnt(12)
    v_mfma_f32_16x16x32_bf16 v[64:67], v[20:23], v[16:19], v[64:67]
    ds_read_b64_tr_b16 v[56:57], v12 offset:26112
    ds_read_b64_tr_b16 v[58:59], v12 offset:26304
    ds_read_b128 v[60:63], v14 offset:8192
    s_waitcnt lgkmcnt(12)
    v_mfma_f32_16x16x32_bf16 v[64:67], v[28:31], v[24:27], v[64:67]
    s_waitcnt lgkmcnt(9)
    v_mfma_f32_16x16x32_bf16 v[64:67], v[36:39], v[32:35], v[64:67]
    s_waitcnt lgkmcnt(6)
    v_mfma_f32_16x16x32_bf16 v[64:67], v[44:47], v[40:43], v[64:67]
    s_waitcnt lgkmcnt(3)
    v_mfma_f32_16x16x32_bf16 v[64:67], v[52:55], v[48:51], v[64:67]
    s_waitcnt lgkmcnt(0)
    v_mfma_f32_16x16x32_bf16 v[64:67], v[60:63], v[56:59], v[64:67]
    s_nop 7
    v_cvt_pk_bf16_f32 v68, v64, v65
    v_cvt_pk_bf16_f32 v69, v66, v67
    v_and_b32 v9, 1, v1
    v_subrev_u32 v9, 1, v9
    s_andn2_b64 vcc, s[14:15], s[16:17]
    v_and_b32 v9, 0x3f803f80, v9
    v_cndmask_b32 v68, v68, v9, vcc
    v_cndmask_b32 v69, v69, v9, vcc
    s_mov_b64 exec, s[14:15]
    buffer_store_dwordx2 v[68:69], v15, s[20:23], s12 offen sc1
    s_mov_b64 exec, -1
    v_max3_f32 v6, abs(v64), abs(v65), abs(v66)
    v_max_f32 v6, v6, abs(v67)
    s_mov_b64 exec, s[16:17]
    ds_max_u32 v2, v6 offset:52
    s_mov_b64 exec, -1
L_b_jpub:
W_53:
    ds_read_b32 v4, v2 offset:44
    s_waitcnt lgkmcnt(0)
    v_readfirstlane_b32 s3, v4
    s_cmp_ge_u32 s3, 1
    s_cbranch_scc1 WD_54
    s_sub_u32 s8, s8, 1
    s_cselect_b32 s8, 0, s8
    s_cbranch_scc1 WD_54
    s_sleep 1
    s_branch W_53
WD_54:
    s_mov_b32 s9, s3
    s_waitcnt vmcnt(0)
    v_mov_b32 v12, s9
    v_mov_b32 v14, 0
    s_mov_b64 exec, 1
    ds_add_rtn_u32 v4, v2, v3 offset:60
    s_waitcnt lgkmcnt(0)
    v_readfirstlane_b32 s3, v4
    s_cmp_eq_u32 s3, 3
    s_cbranch_scc0 PUB_55
    ds_read_b32 v13, v2 offset:52
    ds_read_b32 v15, v2 offset:56
    s_waitcnt lgkmcnt(0)
    v_add_f32 v13, v13, v15
    buffer_store_dwordx2 v[12:13], v14, s[20:23], s18 offen sc1
    ds_write_b32 v2, v3 offset:24
PUB_55:
    s_mov_b64 exec, -1
    s_branch L_b_nojob
L_b_nojob0:
    s_barrier
L_b_nojob:
    s_lshr_b32 s10, s5, 2
    s_mul_i32 s10, s10, 9
    s_mul_i32 s11, s6, 72
    s_add_u32 s10, s10, s11
    s_add_u32 s73, s10, 8
    s_and_b32 s11, s5, 3
    s_lshl_b32 s11, s11, 1
    s_add_u32 s74, s10, s11
    s_min_u32 s10, s72, 2
    s_mul_i32 s75, s10, 22784
    s_add_u32 s79, s74, s10
    s_cmp_eq_u32 s10, 2
    s_cselect_b32 s79, s73, s79
    s_lshl_b32 s10, s79, 12
    s_add_u32 s24, s54, s10
    s_addc_u32 s25, s55, 0
    s_mov_b32 s26, 4096
    s_mov_b32 s27, 0x20000
    s_mov_b32 s68, s56
    s_mov_b32 s69, s57
    s_mov_b32 s70, 1152
    s_mov_b32 s71, 0x20000
    v_mov_b32 v64, 0
    v_mov_b32 v65, 0
    v_mov_b32 v66, 0
    v_mov_b32 v67, 0
    v_lshlrev_b32 v76, 4, v1
    v_bfe_u32 v84, v1, 3, 2
    v_and_b32 v85, 7, v1
    v_add_u32 v77, v84, v85
    v_subrev_u32 v77, 3, v77
    v_lshlrev_b32 v78, 1, v77
    v_mul_u32_u24 v79, 4160, v84
    v_lshl_add_u32 v79, v85, 1, v79
    v_add_u32 v79, 64, v79
    v_add_u32 v79, s75, v79
    v_add_u32 v68, 0xfffffffa, v76
    v_add_u32 v69, 1018, v76
    v_add_u32 v70, 0xfffffffc, v76
    v_add_u32 v71, 1020, v76
    v_add_u32 v72, 0xfffffffe, v76
    v_add_u32 v73, 1022, v76
    v_add_u32 v74, 0x0, v76
    v_add_u32 v75, 1024, v76
    v_lshrrev_b32 v84, 5, v1
    v_mul_u32_u24 v84, 1536, v84
    v_and_b32 v85, 31, v1
    v_lshl_add_u32 v80, v85, 4, v84
    v_add_u32 v80, s75, v80
    s_lshl_b32 s10, s6, 12
    s_add_u32 s10, s10, 7356416
    v_lshlrev_b32 v82, 7, v85
    v_add_u32 v82, s10, v82
    v_bfe_u32 v84, v1, 2, 2
    v_mul_u32_u24 v84, 4160, v84
    v_and_b32 v85, 3, v1
    v_lshl_add_u32 v81, v85, 4, v84
    v_add_u32 v81, s75, v81
    s_mov_b32 s28, s48
    s_mov_b32 s29, s49
    s_mov_b32 s30, 2359296
    s_mov_b32 s31, 0x20000
    s_mov_b32 s32, s50
    s_mov_b32 s33, s51
    s_mov_b32 s34, 2359296
    s_mov_b32 s35, 0x20000
    s_mov_b32 s64, s52
    s_mov_b32 s65, s53
    s_mov_b32 s66, 4608
    s_mov_b32 s67, 0x20000
    s_lshl_b32 s10, s5, 6
    s_mul_i32 s10, s10, 1152
    s_mul_i32 s15, s6, 144
    s_add_u32 s10, s10, s15
    s_mul_i32 s15, s6, 576
    s_mov_b32 s14, 4608
    s_add_u32 s11, s72, 0
    s_lshl_b32 s11, s11, 6
    v_add_u32 v14, s11, v1
    v_min_u32 v14, 287, v14
    v_mul_u32_u24 v15, 1821, v14
    v_lshrrev_b32 v15, 16, v15
    v_mul_u32_u24 v125, 36, v15
    v_sub_u32 v14, v14, v125
    v_lshlrev_b32 v5, 8, v14
    v_lshl_add_u32 v5, v15, 4, v5
    v_add_u32 v7, 68352, v5
    v_mul_u32_u24 v125, 9216, v15
    v_lshl_add_u32 v125, v14, 2, v125
    v_add_u32 v5, s10, v125
    v_subrev_u32 v6, 3456, v5
    v_lshlrev_b32 v11, 4, v14
    s_add_u32 s11, s72, 1
    s_lshl_b32 s11, s11, 6
    v_add_u32 v14, s11, v1
    v_min_u32 v14, 287, v14
    v_mul_u32_u24 v15, 1821, v14
    v_lshrrev_b32 v15, 16, v15
    v_mul_u32_u24 v125, 36, v15
    v_sub_u32 v14, v14, v125
    v_lshlrev_b32 v8, 8, v14
    v_lshl_add_u32 v8, v15, 4, v8
    v_add_u32 v10, 68352, v8
    v_mul_u32_u24 v125, 9216, v15
    v_lshl_add_u32 v125, v14, 2, v125
    v_add_u32 v8, s10, v125
    v_subrev_u32 v9, 3456, v8
    v_lshlrev_b32 v12, 4, v14
    s_lshl_b32 s10, s72, 10
    s_add_u32 s10, s10, 68352
    v_add_u32 v13, s10, v76
    v_lshrrev_b32 v126, 3, v1
    v_lshlrev_b32 v126, 12, v126
    v_and_b32 v15, 7, v1
    v_lshl_add_u32 v126, v15, 4, v126
    v_lshlrev_b32 v14, 7, v1
    s_mul_i32 s12, s6, 294912
    s_lshl_b32 s10, s5, 7
    s_add_u32 s12, s12, s10
    s_lshl_b32 s10, s72, 15
    s_add_u32 s12, s12, s10
    s_add_u32 s12, s12, 262144
    s_lshl_b32 s18, s6, 5
    s_add_u32 s18, s18, s5
    s_lshl_b32 s18, s18, 7
    s_add_u32 s18, s18, 7356416
W_56:
    ds_read_b32 v4, v2 offset:112
    s_waitcnt lgkmcnt(0)
    v_readfirstlane_b32 s3, v4
    s_cmp_ge_u32 s3, 1
    s_cbranch_scc1 WD_57
    s_sub_u32 s8, s8, 1
    s_cselect_b32 s8, 0, s8
    s_cbranch_scc1 WD_57
    s_sleep 1
    s_branch W_56
WD_57:
    buffer_load_dwordx4 v[16:19], v11, s[64:67], s15 offen
    buffer_load_dword v20, v6, s[28:31], 0 offen offset:0
    buffer_load_dword v21, v6, s[28:31], 0 offen offset:1152
    buffer_load_dword v22, v6, s[28:31], 0 offen offset:2304
    buffer_load_dword v23, v5, s[28:31], 0 offen offset:0
    buffer_load_dword v31, v5, s[32:35], 0 offen offset:0
    buffer_load_dword v24, v5, s[28:31], 0 offen offset:1152
    buffer_load_dword v32, v5, s[32:35], 0 offen offset:1152
    buffer_load_dword v25, v5, s[28:31], 0 offen offset:2304
    buffer_load_dword v33, v5, s[32:35], 0 offen offset:2304
    buffer_load_dword v26, v5, s[28:31], 0 offen offset:3456
    buffer_load_dword v34, v5, s[32:35], 0 offen offset:3456
    buffer_load_dword v27, v5, s[28:31], s14 offen offset:0
    buffer_load_dword v35, v5, s[32:35], s14 offen offset:0
    buffer_load_dword v28, v5, s[28:31], s14 offen offset:1152
    buffer_load_dword v36, v5, s[32:35], s14 offen offset:1152
    buffer_load_dword v29, v5, s[28:31], s14 offen offset:2304
    buffer_load_dword v37, v5, s[32:35], s14 offen offset:2304
    buffer_load_dword v30, v5, s[28:31], s14 offen offset:3456
    buffer_load_dword v38, v5, s[32:35], s14 offen offset:3456
    s_cmp_lg_u32 s72, 3
    s_cbranch_scc1 L_b1_w1
    buffer_load_dwordx4 v[40:43], v12, s[64:67], s15 offen
    buffer_load_dword v44, v9, s[28:31], 0 offen offset:0
    buffer_load_dword v45, v9, s[28:31], 0 offen offset:1152
    buffer_load_dword v46, v9, s[28:31], 0 offen offset:2304
    buffer_load_dword v47, v8, s[28:31], 0 offen offset:0
    buffer_load_dword v55, v8, s[32:35], 0 offen offset:0
    buffer_load_dword v48, v8, s[28:31], 0 offen offset:1152
    buffer_load_dword v56, v8, s[32:35], 0 offen offset:1152
    buffer_load_dword v49, v8, s[28:31], 0 offen offset:2304
    buffer_load_dword v57, v8, s[32:35], 0 offen offset:2304
    buffer_load_dword v50, v8, s[28:31], 0 offen offset:3456
    buffer_load_dword v58, v8, s[32:35], 0 offen offset:3456
    buffer_load_dword v51, v8, s[28:31], s14 offen offset:0
    buffer_load_dword v59, v8, s[32:35], s14 offen offset:0
    buffer_load_dword v52, v8, s[28:31], s14 offen offset:1152
    buffer_load_dword v60, v8, s[32:35], s14 offen offset:1152
    buffer_load_dword v53, v8, s[28:31], s14 offen offset:2304
    buffer_load_dword v61, v8, s[32:35], s14 offen offset:2304
    buffer_load_dword v54, v8, s[28:31], s14 offen offset:3456
    buffer_load_dword v62, v8, s[32:35], s14 offen offset:3456
    s_waitcnt vmcnt(20)
    s_branch L_b1_w2
L_b1_w1:
    s_mov_b32 exec_hi, 0
    buffer_load_dword v87, v14, s[24:27], 0 offen
    s_mov_b64 exec, -1
    s_waitcnt vmcnt(1)
L_b1_w2:
    v_lshlrev_b32 v88, 16, v16
    v_and_b32 v90, 0xffff0000, v16
    v_lshlrev_b32 v89, 16, v18
    v_and_b32 v91, 0xffff0000, v18
    v_lshlrev_b32 v92, 16, v17
    v_and_b32 v94, 0xffff0000, v17
    v_lshlrev_b32 v93, 16, v19
    v_and_b32 v95, 0xffff0000, v19
    v_lshlrev_b32 v96, 16, v20
    v_and_b32 v97, 0xffff0000, v20
    v_lshlrev_b32 v98, 16, v21
    v_and_b32 v99, 0xffff0000, v21
    v_lshlrev_b32 v100, 16, v22
    v_and_b32 v101, 0xffff0000, v22
    v_lshlrev_b32 v102, 16, v23
    v_and_b32 v103, 0xffff0000, v23
    v_lshlrev_b32 v104, 16, v24
    v_and_b32 v105, 0xffff0000, v24
    v_lshlrev_b32 v106, 16, v25
    v_and_b32 v107, 0xffff0000, v25
    v_lshlrev_b32 v108, 16, v26
    v_and_b32 v109, 0xffff0000, v26
    v_lshlrev_b32 v110, 16, v27
    v_and_b32 v111, 0xffff0000, v27
    v_lshlrev_b32 v112, 16, v28
    v_and_b32 v113, 0xffff0000, v28
    v_lshlrev_b32 v114, 16, v29
    v_and_b32 v115, 0xffff0000, v29
    v_lshlrev_b32 v116, 16, v30
    v_and_b32 v117, 0xffff0000, v30
    v_pk_mul_f32 v[96:97], v[96:97], v[94:95]
    v_lshlrev_b32 v118, 16, v31
    v_and_b32 v119, 0xffff0000, v31
    v_pk_fma_f32 v[96:97], v[98:99], v[92:93], v[96:97]
    v_pk_fma_f32 v[96:97], v[100:101], v[90:91], v[96:97]
    v_pk_fma_f32 v[96:97], v[102:103], v[88:89], v[96:97]
    v_pk_mul_f32 v[96:97], v[96:97], v[118:119]
    v_pk_mul_f32 v[98:99], v[98:99], v[94:95]
    v_lshlrev_b32 v118, 16, v32
    v_and_b32 v119, 0xffff0000, v32
    v_pk_fma_f32 v[98:99], v[100:101], v[92:93], v[98:99]
    v_pk_fma_f32 v[98:99], v[102:103], v[90:91], v[98:99]
    v_pk_fma_f32 v[98:99], v[104:105], v[88:89], v[98:99]
    v_pk_mul_f32 v[98:99], v[98:99], v[118:119]
    v_pk_mul_f32 v[100:101], v[100:101], v[94:95]
    v_lshlrev_b32 v118, 16, v33
    v_and_b32 v119, 0xffff0000, v33
    v_pk_fma_f32 v[100:101], v[102:103], v[92:93], v[100:101]
    v_pk_fma_f32 v[100:101], v[104:105], v[90:91], v[100:101]
    v_pk_fma_f32 v[100:101], v[106:107], v[88:89], v[100:101]
    v_pk_mul_f32 v[100:101], v[100:101], v[118:119]
    v_pk_mul_f32 v[102:103], v[102:103], v[94:95]
    v_lshlrev_b32 v118, 16, v34
    v_and_b32 v119, 0xffff0000, v34
    v_pk_fma_f32 v[102:103], v[104:105], v[92:93], v[102:103]
    v_pk_fma_f32 v[102:103], v[106:107], v[90:91], v[102:103]
    v_pk_fma_f32 v[102:103], v[108:109], v[88:89], v[102:103]
    v_pk_mul_f32 v[102:103], v[102:103], v[118:119]
    v_pk_mul_f32 v[104:105], v[104:105], v[94:95]
    v_lshlrev_b32 v118, 16, v35
    v_and_b32 v119, 0xffff0000, v35
    v_pk_fma_f32 v[104:105], v[106:107], v[92:93], v[104:105]
    v_pk_fma_f32 v[104:105], v[108:109], v[90:91], v[104:105]
    v_pk_fma_f32 v[104:105], v[110:111], v[88:89], v[104:105]
    v_pk_mul_f32 v[104:105], v[104:105], v[118:119]
    v_pk_mul_f32 v[106:107], v[106:107], v[94:95]
    v_lshlrev_b32 v118, 16, v36
    v_and_b32 v119, 0xffff0000, v36
    v_pk_fma_f32 v[106:107], v[108:109], v[92:93], v[106:107]
    v_pk_fma_f32 v[106:107], v[110:111], v[90:91], v[106:107]
    v_pk_fma_f32 v[106:107], v[112:113], v[88:89], v[106:107]
    v_pk_mul_f32 v[106:107], v[106:107], v[118:119]
    v_pk_mul_f32 v[108:109], v[108:109], v[94:95]
    v_lshlrev_b32 v118, 16, v37
    v_and_b32 v119, 0xffff0000, v37
    v_pk_fma_f32 v[108:109], v[110:111], v[92:93], v[108:109]
    v_pk_fma_f32 v[108:109], v[112:113], v[90:91], v[108:109]
    v_pk_fma_f32 v[108:109], v[114:115], v[88:89], v[108:109]
    v_pk_mul_f32 v[108:109], v[108:109], v[118:119]
    v_pk_mul_f32 v[110:111], v[110:111], v[94:95]
    v_lshlrev_b32 v118, 16, v38
    v_and_b32 v119, 0xffff0000, v38
    v_pk_fma_f32 v[110:111], v[112:113], v[92:93], v[110:111]
    v_pk_fma_f32 v[110:111], v[114:115], v[90:91], v[110:111]
    v_pk_fma_f32 v[110:111], v[116:117], v[88:89], v[110:111]
    v_pk_mul_f32 v[110:111], v[110:111], v[118:119]
    v_cvt_pk_bf16_f32 v16, v110, v108
    v_cvt_pk_bf16_f32 v17, v106, v104
    v_cvt_pk_bf16_f32 v18, v102, v100
    v_cvt_pk_bf16_f32 v19, v98, v96
    v_cvt_pk_bf16_f32 v20, v111, v109
    v_cvt_pk_bf16_f32 v21, v107, v105
    v_cvt_pk_bf16_f32 v22, v103, v101
    v_cvt_pk_bf16_f32 v23, v99, v97
W_58:
    ds_read_b32 v4, v2 offset:36
    s_waitcnt lgkmcnt(0)
    v_readfirstlane_b32 s3, v4
    s_cmp_ge_u32 s3, 8
    s_cbranch_scc1 WD_59
    s_sub_u32 s8, s8, 1
    s_cselect_b32 s8, 0, s8
    s_cbranch_scc1 WD_59
    s_sleep 1
    s_branch W_58
WD_59:
    ds_write_b128 v7, v[16:19]
    ds_write_b128 v7, v[20:23] offset:128
    s_cmp_lg_u32 s72, 3
    s_cbranch_scc1 L_b1_s1
    s_waitcnt vmcnt(0)
    v_lshlrev_b32 v88, 16, v40
    v_and_b32 v90, 0xffff0000, v40
    v_lshlrev_b32 v89, 16, v42
    v_and_b32 v91, 0xffff0000, v42
    v_lshlrev_b32 v92, 16, v41
    v_and_b32 v94, 0xffff0000, v41
    v_lshlrev_b32 v93, 16, v43
    v_and_b32 v95, 0xffff0000, v43
    v_lshlrev_b32 v96, 16, v44
    v_and_b32 v97, 0xffff0000, v44
    v_lshlrev_b32 v98, 16, v45
    v_and_b32 v99, 0xffff0000, v45
    v_lshlrev_b32 v100, 16, v46
    v_and_b32 v101, 0xffff0000, v46
    v_lshlrev_b32 v102, 16, v47
    v_and_b32 v103, 0xffff0000, v47
    v_lshlrev_b32 v104, 16, v48
    v_and_b32 v105, 0xffff0000, v48
    v_lshlrev_b32 v106, 16, v49
    v_and_b32 v107, 0xffff0000, v49
    v_lshlrev_b32 v108, 16, v50
    v_and_b32 v109, 0xffff0000, v50
    v_lshlrev_b32 v110, 16, v51
    v_and_b32 v111, 0xffff0000, v51
    v_lshlrev_b32 v112, 16, v52
    v_and_b32 v113, 0xffff0000, v52
    v_lshlrev_b32 v114, 16, v53
    v_and_b32 v115, 0xffff0000, v53
    v_lshlrev_b32 v116, 16, v54
    v_and_b32 v117, 0xffff0000, v54
    v_pk_mul_f32 v[96:97], v[96:97], v[94:95]
    v_lshlrev_b32 v118, 16, v55
    v_and_b32 v119, 0xffff0000, v55
    v_pk_fma_f32 v[96:97], v[98:99], v[92:93], v[96:97]
    v_pk_fma_f32 v[96:97], v[100:101], v[90:91], v[96:97]
    v_pk_fma_f32 v[96:97], v[102:103], v[88:89], v[96:97]
    v_pk_mul_f32 v[96:97], v[96:97], v[118:119]
    v_pk_mul_f32 v[98:99], v[98:99], v[94:95]
    v_lshlrev_b32 v118, 16, v56
    v_and_b32 v119, 0xffff0000, v56
    v_pk_fma_f32 v[98:99], v[100:101], v[92:93], v[98:99]
    v_pk_fma_f32 v[98:99], v[102:103], v[90:91], v[98:99]
    v_pk_fma_f32 v[98:99], v[104:105], v[88:89], v[98:99]
    v_pk_mul_f32 v[98:99], v[98:99], v[118:119]
    v_pk_mul_f32 v[100:101], v[100:101], v[94:95]
    v_lshlrev_b32 v118, 16, v57
    v_and_b32 v119, 0xffff0000, v57
    v_pk_fma_f32 v[100:101], v[102:103], v[92:93], v[100:101]
    v_pk_fma_f32 v[100:101], v[104:105], v[90:91], v[100:101]
    v_pk_fma_f32 v[100:101], v[106:107], v[88:89], v[100:101]
    v_pk_mul_f32 v[100:101], v[100:101], v[118:119]
    v_pk_mul_f32 v[102:103], v[102:103], v[94:95]
    v_lshlrev_b32 v118, 16, v58
    v_and_b32 v119, 0xffff0000, v58
    v_pk_fma_f32 v[102:103], v[104:105], v[92:93], v[102:103]
    v_pk_fma_f32 v[102:103], v[106:107], v[90:91], v[102:103]
    v_pk_fma_f32 v[102:103], v[108:109], v[88:89], v[102:103]
    v_pk_mul_f32 v[102:103], v[102:103], v[118:119]
    v_pk_mul_f32 v[104:105], v[104:105], v[94:95]
    v_lshlrev_b32 v118, 16, v59
    v_and_b32 v119, 0xffff0000, v59
    v_pk_fma_f32 v[104:105], v[106:107], v[92:93], v[104:105]
    v_pk_fma_f32 v[104:105], v[108:109], v[90:91], v[104:105]
    v_pk_fma_f32 v[104:105], v[110:111], v[88:89], v[104:105]
    v_pk_mul_f32 v[104:105], v[104:105], v[118:119]
    v_pk_mul_f32 v[106:107], v[106:107], v[94:95]
    v_lshlrev_b32 v118, 16, v60
    v_and_b32 v119, 0xffff0000, v60
    v_pk_fma_f32 v[106:107], v[108:109], v[92:93], v[106:107]
    v_pk_fma_f32 v[106:107], v[110:111], v[90:91], v[106:107]
    v_pk_fma_f32 v[106:107], v[112:113], v[88:89], v[106:107]
    v_pk_mul_f32 v[106:107], v[106:107], v[118:119]
    v_pk_mul_f32 v[108:109], v[108:109], v[94:95]
    v_lshlrev_b32 v118, 16, v61
    v_and_b32 v119, 0xffff0000, v61
    v_pk_fma_f32 v[108:109], v[110:111], v[92:93], v[108:109]
    v_pk_fma_f32 v[108:109], v[112:113], v[90:91], v[108:109]
    v_pk_fma_f32 v[108:109], v[114:115], v[88:89], v[108:109]
    v_pk_mul_f32 v[108:109], v[108:109], v[118:119]
    v_pk_mul_f32 v[110:111], v[110:111], v[94:95]
    v_lshlrev_b32 v118, 16, v62
    v_and_b32 v119, 0xffff0000, v62
    v_pk_fma_f32 v[110:111], v[112:113], v[92:93], v[110:111]
    v_pk_fma_f32 v[110:111], v[114:115], v[90:91], v[110:111]
    v_pk_fma_f32 v[110:111], v[116:117], v[88:89], v[110:111]
    v_pk_mul_f32 v[110:111], v[110:111], v[118:119]
    v_cvt_pk_bf16_f32 v40, v110, v108
    v_cvt_pk_bf16_f32 v41, v106, v104
    v_cvt_pk_bf16_f32 v42, v102, v100
    v_cvt_pk_bf16_f32 v43, v98, v96
    v_cvt_pk_bf16_f32 v44, v111, v109
    v_cvt_pk_bf16_f32 v45, v107, v105
    v_cvt_pk_bf16_f32 v46, v103, v101
    v_cvt_pk_bf16_f32 v47, v99, v97
    ds_write_b128 v10, v[40:43]
    ds_write_b128 v10, v[44:47] offset:128
L_b1_s1:
    s_waitcnt lgkmcnt(0)
    s_mov_b64 exec, 1
    ds_add_u32 v2, v3 offset:124
    s_mov_b64 exec, -1
W_60:
    ds_read_b32 v4, v2 offset:44
    s_waitcnt lgkmcnt(0)
    v_readfirstlane_b32 s3, v4
    s_cmp_ge_u32 s3, 1
    s_cbranch_scc1 WD_61
    s_sub_u32 s8, s8, 1
    s_cselect_b32 s8, 0, s8
    s_cbranch_scc1 WD_61
    s_sleep 1
    s_branch W_60
WD_61:
    s_mov_b32 s9, s3
W_62:
    ds_read_b32 v4, v2 offset:124
    s_waitcnt lgkmcnt(0)
    v_readfirstlane_b32 s3, v4
    s_cmp_ge_u32 s3, 4
    s_cbranch_scc1 WD_63
    s_sub_u32 s8, s8, 1
    s_cselect_b32 s8, 0, s8
    s_cbranch_scc1 WD_63
    s_sleep 1
    s_branch W_62
WD_63:
    ds_read_b128 v[16:19], v13 offset:0
    ds_read_b128 v[20:23], v13 offset:4096
    ds_read_b128 v[24:27], v13 offset:8192
W_64:
    ds_read_b32 v4, v2 offset:40
    s_waitcnt lgkmcnt(0)
    v_readfirstlane_b32 s3, v4
    s_cmp_ge_u32 s3, 2
    s_cbranch_scc1 WD_65
    s_sub_u32 s8, s8, 1
    s_cselect_b32 s8, 0, s8
    s_cbranch_scc1 WD_65
    s_sleep 2
    s_branch W_64
WD_65:
    buffer_store_dwordx4 v[16:19], v126, s[20:23], s12 offen sc1
    s_add_u32 s12, s12, 131072
    buffer_store_dwordx4 v[20:23], v126, s[20:23], s12 offen sc1
    s_add_u32 s12, s12, 131072
    s_cmp_lg_u32 s72, 0
    s_cbranch_scc1 L_b1_s2
    buffer_store_dwordx4 v[24:27], v126, s[20:23], s12 offen sc1
    s_add_u32 s12, s12, 131072
L_b1_s2:
    s_waitcnt vmcnt(0)
    v_mov_b32 v28, s9
    v_mov_b32 v30, 0
    s_mov_b64 exec, 1
    ds_add_rtn_u32 v4, v2, v3 offset:64
    s_waitcnt lgkmcnt(0)
    v_readfirstlane_b32 s3, v4
    s_cmp_eq_u32 s3, 3
    s_cbranch_scc0 PUB_66
    buffer_store_dword v28, v30, s[20:23], s18 offen sc1
PUB_66:
    s_mov_b64 exec, -1
W_67:
    ds_read_b32 v4, v2 offset:64
    s_waitcnt lgkmcnt(0)
    v_readfirstlane_b32 s3, v4
    s_cmp_ge_u32 s3, 4
    s_cbranch_scc1 WD_68
    s_sub_u32 s8, s8, 1
    s_cselect_b32 s8, 0, s8
    s_cbranch_scc1 WD_68
    s_sleep 1
    s_branch W_67
WD_68:
    s_cmp_ge_u32 s72, 3
    s_cbranch_scc1 HD_69
    buffer_load_ushort v83, v78, s[24:27], 0 offen
    s_lshl_b32 s10, s79, 1
    buffer_load_ushort v84, v64, s[68:71], s10 offen
    s_add_u32 m0, s75, 64
    s_nop 0
    buffer_load_dwordx4 v68, s[24:27], 0 offen lds
    s_add_u32 m0, s75, 1088
    s_nop 0
    buffer_load_dwordx4 v69, s[24:27], 0 offen lds
    buffer_load_dwordx4 v69, s[24:27], 0 offen offset:1024 lds
    buffer_load_dwordx4 v69, s[24:27], 0 offen offset:2048 lds
    s_add_u32 m0, s75, 4224
    s_nop 0
    buffer_load_dwordx4 v70, s[24:27], 0 offen lds
    s_add_u32 m0, s75, 5248
    s_nop 0
    buffer_load_dwordx4 v71, s[24:27], 0 offen lds
    buffer_load_dwordx4 v71, s[24:27], 0 offen offset:1024 lds
    buffer_load_dwordx4 v71, s[24:27], 0 offen offset:2048 lds
    s_add_u32 m0, s75, 8384
    s_nop 0
    buffer_load_dwordx4 v72, s[24:27], 0 offen lds
    s_add_u32 m0, s75, 9408
    s_nop 0
    buffer_load_dwordx4 v73, s[24:27], 0 offen lds
    buffer_load_dwordx4 v73, s[24:27], 0 offen offset:1024 lds
    buffer_load_dwordx4 v73, s[24:27], 0 offen offset:2048 lds
    s_add_u32 m0, s75, 12544
    s_nop 0
    buffer_load_dwordx4 v74, s[24:27], 0 offen lds
    s_add_u32 m0, s75, 13568
    s_nop 0
    buffer_load_dwordx4 v75, s[24:27], 0 offen lds
    buffer_load_dwordx4 v75, s[24:27], 0 offen offset:1024 lds
    buffer_load_dwordx4 v75, s[24:27], 0 offen offset:2048 lds
    ds_write_b128 v80, v[64:67] offset:16640
    ds_write_b128 v80, v[64:67] offset:19712
    s_mov_b64 exec, 0xffff
    ds_write_b128 v81, v[64:67]
    s_mov_b64 exec, -1
HD_69:
L_b_conv:
    s_add_u32 s18, s18, 32768
    s_cmp_ge_u32 s72, 3
    s_cbranch_scc1 L_c_go
P_70:
    buffer_load_dword v85, v82, s[20:23], 0 offen sc1
    s_waitcnt vmcnt(0)
    v_cmp_ne_u32 vcc, s9, v85
    s_cbranch_vccz PD_71
    s_sub_u32 s8, s8, 16
    s_cselect_b32 s8, 0, s8
    s_cbranch_scc1 PD_71
    s_sleep 2
    s_branch P_70
PD_71:
    s_lshl_b32 s10, s79, 12
    s_add_u32 s10, s10, 262144
    v_lshlrev_b32 v78, 6, v1
    s_add_u32 m0, s75, 17152
    s_nop 0
    buffer_load_dwordx4 v78, s[20:23], s10 offen sc1 lds
    s_add_u32 m0, s75, 18672
    s_nop 0
    buffer_load_dwordx4 v78, s[20:23], s10 offen offset:16 sc1 lds
    s_add_u32 m0, s75, 20192
    s_nop 0
    buffer_load_dwordx4 v78, s[20:23], s10 offen offset:32 sc1 lds
    s_add_u32 m0, s75, 21712
    s_nop 0
    buffer_load_dwordx4 v78, s[20:23], s10 offen offset:48 sc1 lds
    v_lshlrev_b32 v83, 16, v83
    v_lshlrev_b32 v84, 16, v84
    v_add_f32 v84, v84, v83
    v_cmp_eq_u32 vcc, 0, v77
    s_nop 1
    v_cndmask_b32 v83, v83, v84, vcc
    v_cvt_pk_bf16_f32 v83, v83, v83
    s_mov_b32 exec_hi, 0
    ds_write_b16 v79, v83
    s_mov_b64 exec, -1
    s_lshl_b32 s10, s72, 2
    v_add_u32 v77, s10, v2
    s_waitcnt vmcnt(0) lgkmcnt(0)
    ds_write_b32 v77, v3 offset:88
L_c_go:
    s_mov_b32 s28, s46
    s_mov_b32 s29, s47
    s_mov_b32 s30, 2359296
    s_mov_b32 s31, 0x20000
    s_mov_b32 s32, s58
    s_mov_b32 s33, s59
    s_mov_b32 s34, 4718592
    s_mov_b32 s35, 0x20000
    v_lshlrev_b32 v10, 4, v1
    s_lshl_b32 s10, s5, 6
    v_add_u32 v5, s10, v1
    v_mul_u32_u24 v125, 1152, v5
    v_mul_u32_u24 v124, 2304, v5
    s_mul_i32 s76, s6, 144
    s_min_u32 s10, s72, 2
    s_mul_i32 s10, s10, 48
    s_add_u32 s76, s76, s10
    v_and_b32 v5, 3, v1
    v_mul_u32_u24 v5, 4160, v5
    v_and_b32 v6, 28, v1
    v_lshl_add_u32 v5, v6, 1, v5
    v_lshrrev_b32 v6, 5, v1
    v_lshlrev_b32 v7, 4, v6
    v_sub_u32 v5, v5, v7
    v_add_u32 v15, 24, v5
    v_mul_u32_u24 v6, 1536, v6
    v_and_b32 v7, 31, v1
    v_lshl_add_u32 v6, v7, 4, v6
    v_add_u32 v11, 17040, v6
    s_cmp_eq_u32 s72, 0
    s_cbranch_scc1 L_c_q
    s_cmp_eq_u32 s72, 3
    s_cbranch_scc1 L_c_lo
    s_sub_u32 s77, s72, 1
    s_mul_i32 s10, s77, 22784
    v_add_u32 v15, s10, v15
    v_add_u32 v11, s10, v11
    s_add_u32 s12, s74, s77
    s_lshl_b32 s12, s12, 12
    s_add_u32 s12, s12, 2621440
    s_setprio 0
W_72:
    ds_read_b32 v4, v2 offset:92
    s_waitcnt lgkmcnt(0)
    v_readfirstlane_b32 s3, v4
    s_cmp_ge_u32 s3, 1
    s_cbranch_scc1 WD_73
    s_sub_u32 s8, s8, 1
    s_cselect_b32 s8, 0, s8
    s_cbranch_scc1 WD_73
    s_sleep 4
    s_branch W_72
WD_73:
    s_setprio 3
    v_add_u32 v12, 0, v15
    v_add_u32 v13, 0, v11
    s_setprio 0
W_74:
    ds_read_b32 v4, v2 offset:88
    s_waitcnt lgkmcnt(0)
    v_readfirstlane_b32 s3, v4
    s_cmp_ge_u32 s3, 1
    s_cbranch_scc1 WD_75
    s_sub_u32 s8, s8, 1
    s_cselect_b32 s8, 0, s8
    s_cbranch_scc1 WD_75
    s_sleep 4
    s_branch W_74
WD_75:
    s_setprio 3
    ds_read_b64 v[64:65], v12 offset:0
    ds_read_b64 v[66:67], v12 offset:8
    ds_read_b128 v[76:79], v13 offset:3696
    ds_read_b128 v[72:75], v13 offset:3184
    ds_read_b64 v[68:69], v12 offset:2048
    ds_read_b64 v[70:71], v12 offset:2056
    ds_read_b64 v[80:81], v12 offset:32
    ds_read_b64 v[82:83], v12 offset:40
    ds_read_b128 v[92:95], v13 offset:624
    ds_read_b128 v[88:91], v13 offset:112
    ds_read_b64 v[84:85], v12 offset:2080
    ds_read_b64 v[86:87], v12 offset:2088
    s_waitcnt lgkmcnt(6)
    s_setprio 0
    v_mfma_f32_32x32x16_bf16 v[48:63], v[64:67], v[76:79], 0
    ds_read_b64 v[96:97], v12 offset:64
    ds_read_b64 v[98:99], v12 offset:72
    ds_read_b128 v[108:111], v13 offset:3680
    ds_read_b128 v[104:107], v13 offset:3168
    ds_read_b64 v[100:101], v12 offset:2112
    ds_read_b64 v[102:103], v12 offset:2120
    v_mfma_f32_32x32x16_bf16 v[48:63], v[68:71], v[72:75], v[48:63]
    s_waitcnt lgkmcnt(6)
    v_mfma_f32_32x32x16_bf16 v[48:63], v[80:83], v[92:95], v[48:63]
    ds_read_b64 v[64:65], v12 offset:96
    ds_read_b64 v[66:67], v12 offset:104
    ds_read_b128 v[76:79], v13 offset:608
    ds_read_b128 v[72:75], v13 offset:96
    ds_read_b64 v[68:69], v12 offset:2144
    ds_read_b64 v[70:71], v12 offset:2152
    v_mfma_f32_32x32x16_bf16 v[48:63], v[84:87], v[88:91], v[48:63]
    s_waitcnt lgkmcnt(6)
    v_mfma_f32_32x32x16_bf16 v[48:63], v[96:99], v[108:111], v[48:63]
    ds_read_b64 v[80:81], v12 offset:128
    ds_read_b64 v[82:83], v12 offset:136
    ds_read_b128 v[92:95], v13 offset:3664
    ds_read_b128 v[88:91], v13 offset:3152
    ds_read_b64 v[84:85], v12 offset:2176
    ds_read_b64 v[86:87], v12 offset:2184
    v_mfma_f32_32x32x16_bf16 v[48:63], v[100:103], v[104:107], v[48:63]
    s_waitcnt lgkmcnt(6)
    v_mfma_f32_32x32x16_bf16 v[48:63], v[64:67], v[76:79], v[48:63]
    ds_read_b64 v[96:97], v12 offset:160
    ds_read_b64 v[98:99], v12 offset:168
    ds_read_b128 v[108:111], v13 offset:592
    ds_read_b128 v[104:107], v13 offset:80
    ds_read_b64 v[100:101], v12 offset:2208
    ds_read_b64 v[102:103], v12 offset:2216
    v_mfma_f32_32x32x16_bf16 v[48:63], v[68:71], v[72:75], v[48:63]
    s_mov_b32 s78, 5
L_c_hi_l:
    s_waitcnt lgkmcnt(6)
    v_mfma_f32_32x32x16_bf16 v[48:63], v[80:83], v[92:95], v[48:63]
    ds_read_b64 v[64:65], v12 offset:192
    ds_read_b64 v[66:67], v12 offset:200
    ds_read_b128 v[76:79], v13 offset:3648
    ds_read_b128 v[72:75], v13 offset:3136
    ds_read_b64 v[68:69], v12 offset:2240
    ds_read_b64 v[70:71], v12 offset:2248
    v_mfma_f32_32x32x16_bf16 v[48:63], v[84:87], v[88:91], v[48:63]
    s_waitcnt lgkmcnt(6)
    v_mfma_f32_32x32x16_bf16 v[48:63], v[96:99], v[108:111], v[48:63]
    ds_read_b64 v[80:81], v12 offset:224
    ds_read_b64 v[82:83], v12 offset:232
    ds_read_b128 v[92:95], v13 offset:576
    ds_read_b128 v[88:91], v13 offset:64
    ds_read_b64 v[84:85], v12 offset:2272
    ds_read_b64 v[86:87], v12 offset:2280
    v_mfma_f32_32x32x16_bf16 v[48:63], v[100:103], v[104:107], v[48:63]
    s_waitcnt lgkmcnt(6)
    v_mfma_f32_32x32x16_bf16 v[48:63], v[64:67], v[76:79], v[48:63]
    ds_read_b64 v[96:97], v12 offset:256
    ds_read_b64 v[98:99], v12 offset:264
    ds_read_b128 v[108:111], v13 offset:3632
    ds_read_b128 v[104:107], v13 offset:3120
    ds_read_b64 v[100:101], v12 offset:2304
    ds_read_b64 v[102:103], v12 offset:2312
    v_mfma_f32_32x32x16_bf16 v[48:63], v[68:71], v[72:75], v[48:63]
    s_waitcnt lgkmcnt(6)
    v_mfma_f32_32x32x16_bf16 v[48:63], v[80:83], v[92:95], v[48:63]
    ds_read_b64 v[64:65], v12 offset:288
    ds_read_b64 v[66:67], v12 offset:296
    ds_read_b128 v[76:79], v13 offset:560
    ds_read_b128 v[72:75], v13 offset:48
    ds_read_b64 v[68:69], v12 offset:2336
    ds_read_b64 v[70:71], v12 offset:2344
    v_mfma_f32_32x32x16_bf16 v[48:63], v[84:87], v[88:91], v[48:63]
    s_waitcnt lgkmcnt(6)
    v_mfma_f32_32x32x16_bf16 v[48:63], v[96:99], v[108:111], v[48:63]
    ds_read_b64 v[80:81], v12 offset:320
    ds_read_b64 v[82:83], v12 offset:328
    ds_read_b128 v[92:95], v13 offset:3616
    ds_read_b128 v[88:91], v13 offset:3104
    ds_read_b64 v[84:85], v12 offset:2368
    ds_read_b64 v[86:87], v12 offset:2376
    v_mfma_f32_32x32x16_bf16 v[48:63], v[100:103], v[104:107], v[48:63]
    s_waitcnt lgkmcnt(6)
    v_mfma_f32_32x32x16_bf16 v[48:63], v[64:67], v[76:79], v[48:63]
    ds_read_b64 v[96:97], v12 offset:352
    ds_read_b64 v[98:99], v12 offset:360
    ds_read_b128 v[108:111], v13 offset:544
    ds_read_b128 v[104:107], v13 offset:32
    ds_read_b64 v[100:101], v12 offset:2400
    ds_read_b64 v[102:103], v12 offset:2408
    v_mfma_f32_32x32x16_bf16 v[48:63], v[68:71], v[72:75], v[48:63]
    s_waitcnt lgkmcnt(6)
    v_mfma_f32_32x32x16_bf16 v[48:63], v[80:83], v[92:95], v[48:63]
    ds_read_b64 v[64:65], v12 offset:384
    ds_read_b64 v[66:67], v12 offset:392
    ds_read_b128 v[76:79], v13 offset:3600
    ds_read_b128 v[72:75], v13 offset:3088
    ds_read_b64 v[68:69], v12 offset:2432
    ds_read_b64 v[70:71], v12 offset:2440
    v_mfma_f32_32x32x16_bf16 v[48:63], v[84:87], v[88:91], v[48:63]
    s_waitcnt lgkmcnt(6)
    v_mfma_f32_32x32x16_bf16 v[48:63], v[96:99], v[108:111], v[48:63]
    ds_read_b64 v[80:81], v12 offset:416
    ds_read_b64 v[82:83], v12 offset:424
    ds_read_b128 v[92:95], v13 offset:528
    ds_read_b128 v[88:91], v13 offset:16
    ds_read_b64 v[84:85], v12 offset:2464
    ds_read_b64 v[86:87], v12 offset:2472
    v_mfma_f32_32x32x16_bf16 v[48:63], v[100:103], v[104:107], v[48:63]
    s_waitcnt lgkmcnt(6)
    v_mfma_f32_32x32x16_bf16 v[48:63], v[64:67], v[76:79], v[48:63]
    ds_read_b64 v[96:97], v12 offset:448
    ds_read_b64 v[98:99], v12 offset:456
    ds_read_b128 v[108:111], v13 offset:3584
    ds_read_b128 v[104:107], v13 offset:3072
    ds_read_b64 v[100:101], v12 offset:2496
    ds_read_b64 v[102:103], v12 offset:2504
    v_mfma_f32_32x32x16_bf16 v[48:63], v[68:71], v[72:75], v[48:63]
    s_waitcnt lgkmcnt(6)
    v_mfma_f32_32x32x16_bf16 v[48:63], v[80:83], v[92:95], v[48:63]
    ds_read_b64 v[64:65], v12 offset:480
    ds_read_b64 v[66:67], v12 offset:488
    ds_read_b128 v[76:79], v13 offset:512
    ds_read_b128 v[72:75], v13 offset:0
    ds_read_b64 v[68:69], v12 offset:2528
    ds_read_b64 v[70:71], v12 offset:2536
    v_mfma_f32_32x32x16_bf16 v[48:63], v[84:87], v[88:91], v[48:63]
    v_add_u32 v12, 384, v12
    v_subrev_u32 v13, 96, v13
    s_waitcnt lgkmcnt(6)
    v_mfma_f32_32x32x16_bf16 v[48:63], v[96:99], v[108:111], v[48:63]
    ds_read_b64 v[80:81], v12 offset:128
    ds_read_b64 v[82:83], v12 offset:136
    ds_read_b128 v[92:95], v13 offset:3664
    ds_read_b128 v[88:91], v13 offset:3152
    ds_read_b64 v[84:85], v12 offset:2176
    ds_read_b64 v[86:87], v12 offset:2184
    v_mfma_f32_32x32x16_bf16 v[48:63], v[100:103], v[104:107], v[48:63]
    s_waitcnt lgkmcnt(6)
    v_mfma_f32_32x32x16_bf16 v[48:63], v[64:67], v[76:79], v[48:63]
    ds_read_b64 v[96:97], v12 offset:160
    ds_read_b64 v[98:99], v12 offset:168
    ds_read_b128 v[108:111], v13 offset:592
    ds_read_b128 v[104:107], v13 offset:80
    ds_read_b64 v[100:101], v12 offset:2208
    ds_read_b64 v[102:103], v12 offset:2216
    v_mfma_f32_32x32x16_bf16 v[48:63], v[68:71], v[72:75], v[48:63]
    s_sub_u32 s78, s78, 1
    s_cmp_lg_u32 s78, 0
    s_cbranch_scc1 L_c_hi_l
    s_setprio 3
    s_waitcnt lgkmcnt(0)
    s_nop 9
    v_cvt_pk_bf16_f32 v64, v48, v49
    v_cvt_pk_bf16_f32 v65, v50, v51
    v_cvt_pk_bf16_f32 v66, v52, v53
    v_cvt_pk_bf16_f32 v67, v54, v55
    v_cvt_pk_bf16_f32 v68, v56, v57
    v_cvt_pk_bf16_f32 v69, v58, v59
    v_cvt_pk_bf16_f32 v70, v60, v61
    v_cvt_pk_bf16_f32 v71, v62, v63
    s_nop 1
    v_permlane32_swap_b32 v64, v66
    v_permlane32_swap_b32 v65, v67
    v_permlane32_swap_b32 v68, v70
    v_permlane32_swap_b32 v69, v71
    buffer_store_dwordx4 v[64:67], v10, s[20:23], s12 offen offset:2048 sc1
    buffer_store_dwordx4 v[68:71], v10, s[20:23], s12 offen offset:3072 sc1
    s_nop 1
    s_branch L_c_done
L_c_lo:
    s_lshl_b32 s12, s74, 12
    s_add_u32 s12, s12, 2621440
    v_add_u32 v12, 0, v15
    v_add_u32 v13, 0, v11
    s_setprio 0
W_76:
    ds_read_b32 v4, v2 offset:88
    s_waitcnt lgkmcnt(0)
    v_readfirstlane_b32 s3, v4
    s_cmp_ge_u32 s3, 1
    s_cbranch_scc1 WD_77
    s_sub_u32 s8, s8, 1
    s_cselect_b32 s8, 0, s8
    s_cbranch_scc1 WD_77
    s_sleep 4
    s_branch W_76
WD_77:
    s_setprio 3
    ds_read_b64 v[64:65], v12 offset:0
    ds_read_b64 v[66:67], v12 offset:8
    ds_read_b128 v[72:75], v13 offset:3184
    ds_read_b64 v[80:81], v12 offset:32
    ds_read_b64 v[82:83], v12 offset:40
    ds_read_b128 v[88:91], v13 offset:112
    s_waitcnt lgkmcnt(3)
    s_setprio 0
    v_mfma_f32_32x32x16_bf16 v[32:47], v[64:67], v[72:75], 0
    ds_read_b64 v[96:97], v12 offset:64
    ds_read_b64 v[98:99], v12 offset:72
    ds_read_b128 v[104:107], v13 offset:3168
    s_waitcnt lgkmcnt(3)
    v_mfma_f32_32x32x16_bf16 v[32:47], v[80:83], v[88:91], v[32:47]
    ds_read_b64 v[64:65], v12 offset:96
    ds_read_b64 v[66:67], v12 offset:104
    ds_read_b128 v[72:75], v13 offset:96
    s_waitcnt lgkmcnt(3)
    v_mfma_f32_32x32x16_bf16 v[32:47], v[96:99], v[104:107], v[32:47]
    ds_read_b64 v[80:81], v12 offset:128
    ds_read_b64 v[82:83], v12 offset:136
    ds_read_b128 v[88:91], v13 offset:3152
    s_waitcnt lgkmcnt(3)
    v_mfma_f32_32x32x16_bf16 v[32:47], v[64:67], v[72:75], v[32:47]
    ds_read_b64 v[96:97], v12 offset:160
    ds_read_b64 v[98:99], v12 offset:168
    ds_read_b128 v[104:107], v13 offset:80
    s_mov_b32 s78, 5
L_c_lo_l0:
    s_waitcnt lgkmcnt(3)
    v_mfma_f32_32x32x16_bf16 v[32:47], v[80:83], v[88:91], v[32:47]
    ds_read_b64 v[64:65], v12 offset:192
    ds_read_b64 v[66:67], v12 offset:200
    ds_read_b128 v[72:75], v13 offset:3136
    s_waitcnt lgkmcnt(3)
    v_mfma_f32_32x32x16_bf16 v[32:47], v[96:99], v[104:107], v[32:47]
    ds_read_b64 v[80:81], v12 offset:224
    ds_read_b64 v[82:83], v12 offset:232
    ds_read_b128 v[88:91], v13 offset:64
    s_waitcnt lgkmcnt(3)
    v_mfma_f32_32x32x16_bf16 v[32:47], v[64:67], v[72:75], v[32:47]
    ds_read_b64 v[96:97], v12 offset:256
    ds_read_b64 v[98:99], v12 offset:264
    ds_read_b128 v[104:107], v13 offset:3120
    s_waitcnt lgkmcnt(3)
    v_mfma_f32_32x32x16_bf16 v[32:47], v[80:83], v[88:91], v[32:47]
    ds_read_b64 v[64:65], v12 offset:288
    ds_read_b64 v[66:67], v12 offset:296
    ds_read_b128 v[72:75], v13 offset:48
    s_waitcnt lgkmcnt(3)
    v_mfma_f32_32x32x16_bf16 v[32:47], v[96:99], v[104:107], v[32:47]
    ds_read_b64 v[80:81], v12 offset:320
    ds_read_b64 v[82:83], v12 offset:328
    ds_read_b128 v[88:91], v13 offset:3104
    s_waitcnt lgkmcnt(3)
    v_mfma_f32_32x32x16_bf16 v[32:47], v[64:67], v[72:75], v[32:47]
    ds_read_b64 v[96:97], v12 offset:352
    ds_read_b64 v[98:99], v12 offset:360
    ds_read_b128 v[104:107], v13 offset:32
    s_waitcnt lgkmcnt(3)
    v_mfma_f32_32x32x16_bf16 v[32:47], v[80:83], v[88:91], v[32:47]
    ds_read_b64 v[64:65], v12 offset:384
    ds_read_b64 v[66:67], v12 offset:392
    ds_read_b128 v[72:75], v13 offset:3088
    s_waitcnt lgkmcnt(3)
    v_mfma_f32_32x32x16_bf16 v[32:47], v[96:99], v[104:107], v[32:47]
    ds_read_b64 v[80:81], v12 offset:416
    ds_read_b64 v[82:83], v12 offset:424
    ds_read_b128 v[88:91], v13 offset:16
    s_waitcnt lgkmcnt(3)
    v_mfma_f32_32x32x16_bf16 v[32:47], v[64:67], v[72:75], v[32:47]
    ds_read_b64 v[96:97], v12 offset:448
    ds_read_b64 v[98:99], v12 offset:456
    ds_read_b128 v[104:107], v13 offset:3072
    s_waitcnt lgkmcnt(3)
    v_mfma_f32_32x32x16_bf16 v[32:47], v[80:83], v[88:91], v[32:47]
    ds_read_b64 v[64:65], v12 offset:480
    ds_read_b64 v[66:67], v12 offset:488
    ds_read_b128 v[72:75], v13 offset:0
    v_add_u32 v12, 384, v12
    v_subrev_u32 v13, 96, v13
    s_waitcnt lgkmcnt(3)
    v_mfma_f32_32x32x16_bf16 v[32:47], v[96:99], v[104:107], v[32:47]
    ds_read_b64 v[80:81], v12 offset:128
    ds_read_b64 v[82:83], v12 offset:136
    ds_read_b128 v[88:91], v13 offset:3152
    s_waitcnt lgkmcnt(3)
    v_mfma_f32_32x32x16_bf16 v[32:47], v[64:67], v[72:75], v[32:47]
    ds_read_b64 v[96:97], v12 offset:160
    ds_read_b64 v[98:99], v12 offset:168
    ds_read_b128 v[104:107], v13 offset:80
    s_sub_u32 s78, s78, 1
    s_cmp_lg_u32 s78, 0
    s_cbranch_scc1 L_c_lo_l0
    s_setprio 3
    s_waitcnt lgkmcnt(0)
    s_nop 9
    v_cvt_pk_bf16_f32 v64, v32, v33
    v_cvt_pk_bf16_f32 v65, v34, v35
    v_cvt_pk_bf16_f32 v66, v36, v37
    v_cvt_pk_bf16_f32 v67, v38, v39
    v_cvt_pk_bf16_f32 v68, v40, v41
    v_cvt_pk_bf16_f32 v69, v42, v43
    v_cvt_pk_bf16_f32 v70, v44, v45
    v_cvt_pk_bf16_f32 v71, v46, v47
    s_nop 1
    v_permlane32_swap_b32 v64, v66
    v_permlane32_swap_b32 v65, v67
    v_permlane32_swap_b32 v68, v70
    v_permlane32_swap_b32 v69, v71
    buffer_store_dwordx4 v[64:67], v10, s[20:23], s12 offen offset:0 sc1
    buffer_store_dwordx4 v[68:71], v10, s[20:23], s12 offen offset:1024 sc1
    s_nop 1
    s_add_u32 s12, s12, 4096
    v_add_u32 v12, 22784, v15
    v_add_u32 v13, 22784, v11
    s_setprio 0
W_78:
    ds_read_b32 v4, v2 offset:92
    s_waitcnt lgkmcnt(0)
    v_readfirstlane_b32 s3, v4
    s_cmp_ge_u32 s3, 1
    s_cbranch_scc1 WD_79
    s_sub_u32 s8, s8, 1
    s_cselect_b32 s8, 0, s8
    s_cbranch_scc1 WD_79
    s_sleep 4
    s_branch W_78
WD_79:
    s_setprio 3
    ds_read_b64 v[64:65], v12 offset:0
    ds_read_b64 v[66:67], v12 offset:8
    ds_read_b128 v[72:75], v13 offset:3184
    ds_read_b64 v[80:81], v12 offset:32
    ds_read_b64 v[82:83], v12 offset:40
    ds_read_b128 v[88:91], v13 offset:112
    s_waitcnt lgkmcnt(3)
    s_setprio 0
    v_mfma_f32_32x32x16_bf16 v[32:47], v[64:67], v[72:75], 0
    ds_read_b64 v[96:97], v12 offset:64
    ds_read_b64 v[98:99], v12 offset:72
    ds_read_b128 v[104:107], v13 offset:3168
    s_waitcnt lgkmcnt(3)
    v_mfma_f32_32x32x16_bf16 v[32:47], v[80:83], v[88:91], v[32:47]
    ds_read_b64 v[64:65], v12 offset:96
    ds_read_b64 v[66:67], v12 offset:104
    ds_read_b128 v[72:75], v13 offset:96
    s_waitcnt lgkmcnt(3)
    v_mfma_f32_32x32x16_bf16 v[32:47], v[96:99], v[104:107], v[32:47]
    ds_read_b64 v[80:81], v12 offset:128
    ds_read_b64 v[82:83], v12 offset:136
    ds_read_b128 v[88:91], v13 offset:3152
    s_waitcnt lgkmcnt(3)
    v_mfma_f32_32x32x16_bf16 v[32:47], v[64:67], v[72:75], v[32:47]
    ds_read_b64 v[96:97], v12 offset:160
    ds_read_b64 v[98:99], v12 offset:168
    ds_read_b128 v[104:107], v13 offset:80
    s_mov_b32 s78, 5
L_c_lo_l1:
    s_waitcnt lgkmcnt(3)
    v_mfma_f32_32x32x16_bf16 v[32:47], v[80:83], v[88:91], v[32:47]
    ds_read_b64 v[64:65], v12 offset:192
    ds_read_b64 v[66:67], v12 offset:200
    ds_read_b128 v[72:75], v13 offset:3136
    s_waitcnt lgkmcnt(3)
    v_mfma_f32_32x32x16_bf16 v[32:47], v[96:99], v[104:107], v[32:47]
    ds_read_b64 v[80:81], v12 offset:224
    ds_read_b64 v[82:83], v12 offset:232
    ds_read_b128 v[88:91], v13 offset:64
    s_waitcnt lgkmcnt(3)
    v_mfma_f32_32x32x16_bf16 v[32:47], v[64:67], v[72:75], v[32:47]
    ds_read_b64 v[96:97], v12 offset:256
    ds_read_b64 v[98:99], v12 offset:264
    ds_read_b128 v[104:107], v13 offset:3120
    s_waitcnt lgkmcnt(3)
    v_mfma_f32_32x32x16_bf16 v[32:47], v[80:83], v[88:91], v[32:47]
    ds_read_b64 v[64:65], v12 offset:288
    ds_read_b64 v[66:67], v12 offset:296
    ds_read_b128 v[72:75], v13 offset:48
    s_waitcnt lgkmcnt(3)
    v_mfma_f32_32x32x16_bf16 v[32:47], v[96:99], v[104:107], v[32:47]
    ds_read_b64 v[80:81], v12 offset:320
    ds_read_b64 v[82:83], v12 offset:328
    ds_read_b128 v[88:91], v13 offset:3104
    s_waitcnt lgkmcnt(3)
    v_mfma_f32_32x32x16_bf16 v[32:47], v[64:67], v[72:75], v[32:47]
    ds_read_b64 v[96:97], v12 offset:352
    ds_read_b64 v[98:99], v12 offset:360
    ds_read_b128 v[104:107], v13 offset:32
    s_waitcnt lgkmcnt(3)
    v_mfma_f32_32x32x16_bf16 v[32:47], v[80:83], v[88:91], v[32:47]
    ds_read_b64 v[64:65], v12 offset:384
    ds_read_b64 v[66:67], v12 offset:392
    ds_read_b128 v[72:75], v13 offset:3088
    s_waitcnt lgkmcnt(3)
    v_mfma_f32_32x32x16_bf16 v[32:47], v[96:99], v[104:107], v[32:47]
    ds_read_b64 v[80:81], v12 offset:416
    ds_read_b64 v[82:83], v12 offset:424
    ds_read_b128 v[88:91], v13 offset:16
    s_waitcnt lgkmcnt(3)
    v_mfma_f32_32x32x16_bf16 v[32:47], v[64:67], v[72:75], v[32:47]
    ds_read_b64 v[96:97], v12 offset:448
    ds_read_b64 v[98:99], v12 offset:456
    ds_read_b128 v[104:107], v13 offset:3072
    s_waitcnt lgkmcnt(3)
    v_mfma_f32_32x32x16_bf16 v[32:47], v[80:83], v[88:91], v[32:47]
    ds_read_b64 v[64:65], v12 offset:480
    ds_read_b64 v[66:67], v12 offset:488
    ds_read_b128 v[72:75], v13 offset:0
    v_add_u32 v12, 384, v12
    v_subrev_u32 v13, 96, v13
    s_waitcnt lgkmcnt(3)
    v_mfma_f32_32x32x16_bf16 v[32:47], v[96:99], v[104:107], v[32:47]
    ds_read_b64 v[80:81], v12 offset:128
    ds_read_b64 v[82:83], v12 offset:136
    ds_read_b128 v[88:91], v13 offset:3152
    s_waitcnt lgkmcnt(3)
    v_mfma_f32_32x32x16_bf16 v[32:47], v[64:67], v[72:75], v[32:47]
    ds_read_b64 v[96:97], v12 offset:160
    ds_read_b64 v[98:99], v12 offset:168
    ds_read_b128 v[104:107], v13 offset:80
    s_sub_u32 s78, s78, 1
    s_cmp_lg_u32 s78, 0
    s_cbranch_scc1 L_c_lo_l1
    s_setprio 3
    s_waitcnt lgkmcnt(0)
    s_nop 9
    v_cvt_pk_bf16_f32 v64, v32, v33
    v_cvt_pk_bf16_f32 v65, v34, v35
    v_cvt_pk_bf16_f32 v66, v36, v37
    v_cvt_pk_bf16_f32 v67, v38, v39
    v_cvt_pk_bf16_f32 v68, v40, v41
    v_cvt_pk_bf16_f32 v69, v42, v43
    v_cvt_pk_bf16_f32 v70, v44, v45
    v_cvt_pk_bf16_f32 v71, v46, v47
    s_nop 1
    v_permlane32_swap_b32 v64, v66
    v_permlane32_swap_b32 v65, v67
    v_permlane32_swap_b32 v68, v70
    v_permlane32_swap_b32 v69, v71
    buffer_store_dwordx4 v[64:67], v10, s[20:23], s12 offen offset:0 sc1
    buffer_store_dwordx4 v[68:71], v10, s[20:23], s12 offen offset:1024 sc1
    s_nop 1
    s_branch L_c_done
L_c_q:
    s_lshl_b32 s10, s73, 12
    s_add_u32 s10, s10, 2621440
    s_lshl_b32 s11, s6, 3
    s_lshr_b32 s13, s5, 2
    s_add_u32 s11, s11, s13
    s_mul_i32 s11, s11, 3
    s_and_b32 s13, s5, 3
    s_add_u32 s11, s11, s13
    s_lshl_b32 s11, s11, 12
    s_add_u32 s11, s11, 7467008
    s_cmp_lg_u32 s13, 0
    s_cselect_b32 s12, s11, s10
    v_add_u32 v12, 45568, v15
    v_add_u32 v13, 45568, v11
    s_lshl_b32 s10, s13, 9
    v_add_u32 v12, s10, v12
    s_lshl_b32 s10, s13, 7
    v_subrev_u32 v13, s10, v13
    s_setprio 0
W_80:
    ds_read_b32 v4, v2 offset:96
    s_waitcnt lgkmcnt(0)
    v_readfirstlane_b32 s3, v4
    s_cmp_ge_u32 s3, 1
    s_cbranch_scc1 WD_81
    s_sub_u32 s8, s8, 1
    s_cselect_b32 s8, 0, s8
    s_cbranch_scc1 WD_81
    s_sleep 4
    s_branch W_80
WD_81:
    s_setprio 3
    ds_read_b64 v[64:65], v12 offset:0
    ds_read_b64 v[66:67], v12 offset:8
    ds_read_b128 v[76:79], v13 offset:3696
    ds_read_b128 v[72:75], v13 offset:3184
    ds_read_b64 v[68:69], v12 offset:2048
    ds_read_b64 v[70:71], v12 offset:2056
    ds_read_b64 v[80:81], v12 offset:32
    ds_read_b64 v[82:83], v12 offset:40
    ds_read_b128 v[92:95], v13 offset:624
    ds_read_b128 v[88:91], v13 offset:112
    ds_read_b64 v[84:85], v12 offset:2080
    ds_read_b64 v[86:87], v12 offset:2088
    s_waitcnt lgkmcnt(6)
    s_setprio 0
    v_mfma_f32_32x32x16_bf16 v[32:47], v[64:67], v[72:75], 0
    ds_read_b64 v[96:97], v12 offset:64
    ds_read_b64 v[98:99], v12 offset:72
    ds_read_b128 v[108:111], v13 offset:3680
    ds_read_b128 v[104:107], v13 offset:3168
    ds_read_b64 v[100:101], v12 offset:2112
    ds_read_b64 v[102:103], v12 offset:2120
    v_mfma_f32_32x32x16_bf16 v[48:63], v[64:67], v[76:79], 0
    v_mfma_f32_32x32x16_bf16 v[48:63], v[68:71], v[72:75], v[48:63]
    s_waitcnt lgkmcnt(6)
    v_mfma_f32_32x32x16_bf16 v[32:47], v[80:83], v[88:91], v[32:47]
    ds_read_b64 v[64:65], v12 offset:96
    ds_read_b64 v[66:67], v12 offset:104
    ds_read_b128 v[76:79], v13 offset:608
    ds_read_b128 v[72:75], v13 offset:96
    ds_read_b64 v[68:69], v12 offset:2144
    ds_read_b64 v[70:71], v12 offset:2152
    v_mfma_f32_32x32x16_bf16 v[48:63], v[80:83], v[92:95], v[48:63]
    v_mfma_f32_32x32x16_bf16 v[48:63], v[84:87], v[88:91], v[48:63]
    s_waitcnt lgkmcnt(6)
    v_mfma_f32_32x32x16_bf16 v[32:47], v[96:99], v[104:107], v[32:47]
    ds_read_b64 v[80:81], v12 offset:128
    ds_read_b64 v[82:83], v12 offset:136
    ds_read_b128 v[92:95], v13 offset:3664
    ds_read_b128 v[88:91], v13 offset:3152
    ds_read_b64 v[84:85], v12 offset:2176
    ds_read_b64 v[86:87], v12 offset:2184
    v_mfma_f32_32x32x16_bf16 v[48:63], v[96:99], v[108:111], v[48:63]
    v_mfma_f32_32x32x16_bf16 v[48:63], v[100:103], v[104:107], v[48:63]
    s_waitcnt lgkmcnt(6)
    v_mfma_f32_32x32x16_bf16 v[32:47], v[64:67], v[72:75], v[32:47]
    ds_read_b64 v[96:97], v12 offset:160
    ds_read_b64 v[98:99], v12 offset:168
    ds_read_b128 v[108:111], v13 offset:592
    ds_read_b128 v[104:107], v13 offset:80
    ds_read_b64 v[100:101], v12 offset:2208
    ds_read_b64 v[102:103], v12 offset:2216
    v_mfma_f32_32x32x16_bf16 v[48:63], v[64:67], v[76:79], v[48:63]
    v_mfma_f32_32x32x16_bf16 v[48:63], v[68:71], v[72:75], v[48:63]
    s_waitcnt lgkmcnt(6)
    v_mfma_f32_32x32x16_bf16 v[32:47], v[80:83], v[88:91], v[32:47]
    ds_read_b64 v[64:65], v12 offset:192
    ds_read_b64 v[66:67], v12 offset:200
    ds_read_b128 v[76:79], v13 offset:3648
    ds_read_b128 v[72:75], v13 offset:3136
    ds_read_b64 v[68:69], v12 offset:2240
    ds_read_b64 v[70:71], v12 offset:2248
    v_mfma_f32_32x32x16_bf16 v[48:63], v[80:83], v[92:95], v[48:63]
    v_mfma_f32_32x32x16_bf16 v[48:63], v[84:87], v[88:91], v[48:63]
    s_waitcnt lgkmcnt(6)
    v_mfma_f32_32x32x16_bf16 v[32:47], v[96:99], v[104:107], v[32:47]
    ds_read_b64 v[80:81], v12 offset:224
    ds_read_b64 v[82:83], v12 offset:232
    ds_read_b128 v[92:95], v13 offset:576
    ds_read_b128 v[88:91], v13 offset:64
    ds_read_b64 v[84:85], v12 offset:2272
    ds_read_b64 v[86:87], v12 offset:2280
    v_mfma_f32_32x32x16_bf16 v[48:63], v[96:99], v[108:111], v[48:63]
    v_mfma_f32_32x32x16_bf16 v[48:63], v[100:103], v[104:107], v[48:63]
    s_waitcnt lgkmcnt(6)
    v_mfma_f32_32x32x16_bf16 v[32:47], v[64:67], v[72:75], v[32:47]
    ds_read_b64 v[96:97], v12 offset:256
    ds_read_b64 v[98:99], v12 offset:264
    ds_read_b128 v[108:111], v13 offset:3632
    ds_read_b128 v[104:107], v13 offset:3120
    ds_read_b64 v[100:101], v12 offset:2304
    ds_read_b64 v[102:103], v12 offset:2312
    v_mfma_f32_32x32x16_bf16 v[48:63], v[64:67], v[76:79], v[48:63]
    v_mfma_f32_32x32x16_bf16 v[48:63], v[68:71], v[72:75], v[48:63]
    s_waitcnt lgkmcnt(6)
    v_mfma_f32_32x32x16_bf16 v[32:47], v[80:83], v[88:91], v[32:47]
    ds_read_b64 v[64:65], v12 offset:288
    ds_read_b64 v[66:67], v12 offset:296
    ds_read_b128 v[76:79], v13 offset:560
    ds_read_b128 v[72:75], v13 offset:48
    ds_read_b64 v[68:69], v12 offset:2336
    ds_read_b64 v[70:71], v12 offset:2344
    v_mfma_f32_32x32x16_bf16 v[48:63], v[80:83], v[92:95], v[48:63]
    v_mfma_f32_32x32x16_bf16 v[48:63], v[84:87], v[88:91], v[48:63]
    s_waitcnt lgkmcnt(6)
    v_mfma_f32_32x32x16_bf16 v[32:47], v[96:99], v[104:107], v[32:47]
    ds_read_b64 v[80:81], v12 offset:320
    ds_read_b64 v[82:83], v12 offset:328
    ds_read_b128 v[92:95], v13 offset:3616
    ds_read_b128 v[88:91], v13 offset:3104
    ds_read_b64 v[84:85], v12 offset:2368
    ds_read_b64 v[86:87], v12 offset:2376
    v_mfma_f32_32x32x16_bf16 v[48:63], v[96:99], v[108:111], v[48:63]
    v_mfma_f32_32x32x16_bf16 v[48:63], v[100:103], v[104:107], v[48:63]
    s_waitcnt lgkmcnt(6)
    v_mfma_f32_32x32x16_bf16 v[32:47], v[64:67], v[72:75], v[32:47]
    ds_read_b64 v[96:97], v12 offset:352
    ds_read_b64 v[98:99], v12 offset:360
    ds_read_b128 v[108:111], v13 offset:544
    ds_read_b128 v[104:107], v13 offset:32
    ds_read_b64 v[100:101], v12 offset:2400
    ds_read_b64 v[102:103], v12 offset:2408
    v_mfma_f32_32x32x16_bf16 v[48:63], v[64:67], v[76:79], v[48:63]
    v_mfma_f32_32x32x16_bf16 v[48:63], v[68:71], v[72:75], v[48:63]
    s_waitcnt lgkmcnt(6)
    v_mfma_f32_32x32x16_bf16 v[32:47], v[80:83], v[88:91], v[32:47]
    ds_read_b64 v[64:65], v12 offset:384
    ds_read_b64 v[66:67], v12 offset:392
    ds_read_b128 v[76:79], v13 offset:3600
    ds_read_b128 v[72:75], v13 offset:3088
    ds_read_b64 v[68:69], v12 offset:2432
    ds_read_b64 v[70:71], v12 offset:2440
    v_mfma_f32_32x32x16_bf16 v[48:63], v[80:83], v[92:95], v[48:63]
    v_mfma_f32_32x32x16_bf16 v[48:63], v[84:87], v[88:91], v[48:63]
    s_waitcnt lgkmcnt(6)
    v_mfma_f32_32x32x16_bf16 v[32:47], v[96:99], v[104:107], v[32:47]
    ds_read_b64 v[80:81], v12 offset:416
    ds_read_b64 v[82:83], v12 offset:424
    ds_read_b128 v[92:95], v13 offset:528
    ds_read_b128 v[88:91], v13 offset:16
    ds_read_b64 v[84:85], v12 offset:2464
    ds_read_b64 v[86:87], v12 offset:2472
    v_mfma_f32_32x32x16_bf16 v[48:63], v[96:99], v[108:111], v[48:63]
    v_mfma_f32_32x32x16_bf16 v[48:63], v[100:103], v[104:107], v[48:63]
    s_waitcnt lgkmcnt(6)
    v_mfma_f32_32x32x16_bf16 v[32:47], v[64:67], v[72:75], v[32:47]
    ds_read_b64 v[96:97], v12 offset:448
    ds_read_b64 v[98:99], v12 offset:456
    ds_read_b128 v[108:111], v13 offset:3584
    ds_read_b128 v[104:107], v13 offset:3072
    ds_read_b64 v[100:101], v12 offset:2496
    ds_read_b64 v[102:103], v12 offset:2504
    v_mfma_f32_32x32x16_bf16 v[48:63], v[64:67], v[76:79], v[48:63]
    v_mfma_f32_32x32x16_bf16 v[48:63], v[68:71], v[72:75], v[48:63]
    s_waitcnt lgkmcnt(6)
    v_mfma_f32_32x32x16_bf16 v[32:47], v[80:83], v[88:91], v[32:47]
    ds_read_b64 v[64:65], v12 offset:480
    ds_read_b64 v[66:67], v12 offset:488
    ds_read_b128 v[76:79], v13 offset:512
    ds_read_b128 v[72:75], v13 offset:0
    ds_read_b64 v[68:69], v12 offset:2528
    ds_read_b64 v[70:71], v12 offset:2536
    v_mfma_f32_32x32x16_bf16 v[48:63], v[80:83], v[92:95], v[48:63]
    v_mfma_f32_32x32x16_bf16 v[48:63], v[84:87], v[88:91], v[48:63]
    s_waitcnt lgkmcnt(6)
    v_mfma_f32_32x32x16_bf16 v[32:47], v[96:99], v[104:107], v[32:47]
    v_mfma_f32_32x32x16_bf16 v[48:63], v[96:99], v[108:111], v[48:63]
    v_mfma_f32_32x32x16_bf16 v[48:63], v[100:103], v[104:107], v[48:63]
    s_waitcnt lgkmcnt(0)
    v_mfma_f32_32x32x16_bf16 v[32:47], v[64:67], v[72:75], v[32:47]
    v_mfma_f32_32x32x16_bf16 v[48:63], v[64:67], v[76:79], v[48:63]
    v_mfma_f32_32x32x16_bf16 v[48:63], v[68:71], v[72:75], v[48:63]
    s_setprio 3
    s_waitcnt lgkmcnt(0)
    s_nop 9
    v_cvt_pk_bf16_f32 v64, v32, v33
    v_cvt_pk_bf16_f32 v65, v34, v35
    v_cvt_pk_bf16_f32 v66, v36, v37
    v_cvt_pk_bf16_f32 v67, v38, v39
    v_cvt_pk_bf16_f32 v68, v40, v41
    v_cvt_pk_bf16_f32 v69, v42, v43
    v_cvt_pk_bf16_f32 v70, v44, v45
    v_cvt_pk_bf16_f32 v71, v46, v47
    s_nop 1
    v_permlane32_swap_b32 v64, v66
    v_permlane32_swap_b32 v65, v67
    v_permlane32_swap_b32 v68, v70
    v_permlane32_swap_b32 v69, v71
    buffer_store_dwordx4 v[64:67], v10, s[20:23], s12 offen offset:0 sc1
    buffer_store_dwordx4 v[68:71], v10, s[20:23], s12 offen offset:1024 sc1
    s_nop 1
    v_cvt_pk_bf16_f32 v64, v48, v49
    v_cvt_pk_bf16_f32 v65, v50, v51
    v_cvt_pk_bf16_f32 v66, v52, v53
    v_cvt_pk_bf16_f32 v67, v54, v55
    v_cvt_pk_bf16_f32 v68, v56, v57
    v_cvt_pk_bf16_f32 v69, v58, v59
    v_cvt_pk_bf16_f32 v70, v60, v61
    v_cvt_pk_bf16_f32 v71, v62, v63
    s_nop 1
    v_permlane32_swap_b32 v64, v66
    v_permlane32_swap_b32 v65, v67
    v_permlane32_swap_b32 v68, v70
    v_permlane32_swap_b32 v69, v71
    buffer_store_dwordx4 v[64:67], v10, s[20:23], s12 offen offset:2048 sc1
    buffer_store_dwordx4 v[68:71], v10, s[20:23], s12 offen offset:3072 sc1
    s_nop 1
L_c_done:
    s_waitcnt vmcnt(0)
    v_mov_b32 v20, s9
    v_mov_b32 v22, 0
    s_mov_b64 exec, 1
    ds_add_rtn_u32 v4, v2, v3 offset:68
    s_waitcnt lgkmcnt(0)
    v_readfirstlane_b32 s3, v4
    s_cmp_eq_u32 s3, 3
    s_cbranch_scc0 PUB_82
    buffer_store_dword v20, v22, s[20:23], s18 offen sc1
    ds_write_b32 v2, v3 offset:72
PUB_82:
    s_mov_b64 exec, -1
    s_cmp_eq_u32 s72, 3
    s_cbranch_scc1 L_oproj
W_83:
    ds_read_b32 v4, v2 offset:72
    s_waitcnt lgkmcnt(0)
    v_readfirstlane_b32 s3, v4
    s_cmp_ge_u32 s3, 1
    s_cbranch_scc1 WD_84
    s_sub_u32 s8, s8, 1
    s_cselect_b32 s8, 0, s8
    s_cbranch_scc1 WD_84
    s_sleep 2
    s_branch W_83
WD_84:
    buffer_load_dwordx4 v[112:115], v125, s[28:31], s76 offen offset:0
    buffer_load_dwordx4 v[116:119], v125, s[28:31], s76 offen offset:16
    buffer_load_dwordx4 v[120:123], v125, s[28:31], s76 offen offset:32
    s_lshl_b32 s10, s6, 12
    s_add_u32 s10, s10, 7389184
    v_and_b32 v5, 31, v1
    v_lshlrev_b32 v5, 7, v5
    v_add_u32 v5, s10, v5
    v_lshrrev_b32 v7, 3, v1
    v_lshlrev_b32 v7, 12, v7
    v_and_b32 v8, 3, v1
    v_lshl_add_u32 v7, v8, 9, v7
    v_bfe_u32 v8, v1, 2, 1
    v_lshl_add_u32 v7, v8, 4, v7
    s_mul_i32 s12, s6, 72
    s_mul_i32 s10, s72, 24
    s_add_u32 s12, s12, s10
    s_lshl_b32 s12, s12, 12
    s_add_u32 s12, s12, 2621440
    s_lshr_b32 s15, s5, 4
    s_lshl_b32 s15, s15, 11
    s_and_b32 s10, s5, 15
    s_lshl_b32 s10, s10, 5
    s_add_u32 s15, s15, s10
    s_add_u32 s12, s12, s15
    s_mul_i32 s13, s72, 3072
    s_add_u32 s13, s13, 144384
    v_bfe_u32 v8, v1, 2, 2
    v_lshlrev_b32 v8, 7, v8
    v_lshrrev_b32 v9, 4, v1
    v_lshl_add_u32 v8, v9, 5, v8
    v_and_b32 v9, 3, v1
    v_lshl_add_u32 v8, v9, 3, v8
    v_add_u32 v8, s13, v8
    s_mul_i32 s10, s72, 5
    s_lshr_b32 s10, s10, 1
    s_lshl_b32 s11, s6, 3
    s_add_u32 s11, s11, s10
    s_mul_i32 s14, s11, 12288
    s_add_u32 s14, s14, 7471104
    s_add_u32 s14, s14, s15
    s_mul_i32 s10, s10, 9
    s_add_u32 s10, s10, 8
    s_mul_i32 s11, s72, 24
    s_sub_u32 s10, s10, s11
    s_lshl_b32 s10, s10, 7
    s_add_u32 s10, s10, s13
    v_lshrrev_b32 v20, 3, v1
    v_and_b32 v9, 7, v1
    v_lshlrev_b32 v9, 4, v9
    v_mul_u32_u24 v21, 1152, v20
    v_add3_u32 v21, v21, v9, s10
    v_lshl_add_u32 v22, v20, 13, v7
    s_cmp_eq_u32 s72, 0
    s_mov_b32 s16, 0xffffff
    s_cselect_b32 s16, 0xffff, s16
    s_mov_b32 s17, 0
P_85:
    buffer_load_dword v6, v5, s[20:23], 0 offen sc1
    s_waitcnt vmcnt(0)
    v_cmp_ne_u32 vcc, s9, v6
    s_cbranch_vccz PD_86
    s_sub_u32 s8, s8, 16
    s_cselect_b32 s8, 0, s8
    s_cbranch_scc1 PD_86
    s_sleep 3
    s_branch P_85
PD_86:
    s_add_u32 m0, s13, 0
    s_nop 0
    buffer_load_dwordx4 v7, s[20:23], s12 offen sc1 lds
    s_add_u32 s12, s12, 32768
    s_add_u32 m0, s13, 1024
    s_nop 0
    buffer_load_dwordx4 v7, s[20:23], s12 offen sc1 lds
    s_add_u32 s12, s12, 32768
    s_add_u32 m0, s13, 2048
    s_nop 0
    buffer_load_dwordx4 v7, s[20:23], s12 offen sc1 lds
    s_mov_b64 exec, s[16:17]
    buffer_load_dwordx4 v[36:39], v22, s[20:23], s14 offen sc1
    s_add_u32 s14, s14, 4096
    buffer_load_dwordx4 v[40:43], v22, s[20:23], s14 offen sc1
    s_add_u32 s14, s14, 4096
    buffer_load_dwordx4 v[44:47], v22, s[20:23], s14 offen sc1
    s_add_u32 s14, s14, 4096
    s_add_u32 s76, s76, 1152
    s_mov_b64 exec, -1
    s_setprio 0
W_87:
    ds_read_b32 v4, v2 offset:100
    s_waitcnt lgkmcnt(0)
    v_readfirstlane_b32 s3, v4
    s_cmp_ge_u32 s3, 2
    s_cbranch_scc1 WD_88
    s_sub_u32 s8, s8, 1
    s_cselect_b32 s8, 0, s8
    s_cbranch_scc1 WD_88
    s_sleep 1
    s_branch W_87
WD_88:
    s_setprio 3
    s_mov_b64 exec, s[16:17]
    s_waitcnt vmcnt(0)
    ds_read_b128 v[32:35], v21
    s_waitcnt lgkmcnt(0)
    v_lshlrev_b32 v48, 16, v32
    v_and_b32 v49, 0xffff0000, v32
    v_lshlrev_b32 v50, 16, v36
    v_and_b32 v51, 0xffff0000, v36
    v_lshlrev_b32 v52, 16, v40
    v_and_b32 v53, 0xffff0000, v40
    v_lshlrev_b32 v54, 16, v44
    v_and_b32 v55, 0xffff0000, v44
    v_pk_add_f32 v[48:49], v[48:49], v[50:51]
    v_pk_add_f32 v[52:53], v[52:53], v[54:55]
    v_pk_add_f32 v[48:49], v[48:49], v[52:53]
    v_cvt_pk_bf16_f32 v56, v48, v49
    v_lshlrev_b32 v48, 16, v33
    v_and_b32 v49, 0xffff0000, v33
    v_lshlrev_b32 v50, 16, v37
    v_and_b32 v51, 0xffff0000, v37
    v_lshlrev_b32 v52, 16, v41
    v_and_b32 v53, 0xffff0000, v41
    v_lshlrev_b32 v54, 16, v45
    v_and_b32 v55, 0xffff0000, v45
    v_pk_add_f32 v[48:49], v[48:49], v[50:51]
    v_pk_add_f32 v[52:53], v[52:53], v[54:55]
    v_pk_add_f32 v[48:49], v[48:49], v[52:53]
    v_cvt_pk_bf16_f32 v57, v48, v49
    v_lshlrev_b32 v48, 16, v34
    v_and_b32 v49, 0xffff0000, v34
    v_lshlrev_b32 v50, 16, v38
    v_and_b32 v51, 0xffff0000, v38
    v_lshlrev_b32 v52, 16, v42
    v_and_b32 v53, 0xffff0000, v42
    v_lshlrev_b32 v54, 16, v46
    v_and_b32 v55, 0xffff0000, v46
    v_pk_add_f32 v[48:49], v[48:49], v[50:51]
    v_pk_add_f32 v[52:53], v[52:53], v[54:55]
    v_pk_add_f32 v[48:49], v[48:49], v[52:53]
    v_cvt_pk_bf16_f32 v58, v48, v49
    v_lshlrev_b32 v48, 16, v35
    v_and_b32 v49, 0xffff0000, v35
    v_lshlrev_b32 v50, 16, v39
    v_and_b32 v51, 0xffff0000, v39
    v_lshlrev_b32 v52, 16, v43
    v_and_b32 v53, 0xffff0000, v43
    v_lshlrev_b32 v54, 16, v47
    v_and_b32 v55, 0xffff0000, v47
    v_pk_add_f32 v[48:49], v[48:49], v[50:51]
    v_pk_add_f32 v[52:53], v[52:53], v[54:55]
    v_pk_add_f32 v[48:49], v[48:49], v[52:53]
    v_cvt_pk_bf16_f32 v59, v48, v49
    ds_write_b128 v21, v[56:59]
    s_mov_b64 exec, -1
    ds_read_b64_tr_b16 v[16:17], v8 offset:0
    ds_read_b64_tr_b16 v[18:19], v8 offset:512
    ds_read_b64_tr_b16 v[20:21], v8 offset:1024
    ds_read_b64_tr_b16 v[22:23], v8 offset:1536
    ds_read_b64_tr_b16 v[24:25], v8 offset:2048
    ds_read_b64_tr_b16 v[26:27], v8 offset:2560
    s_waitcnt lgkmcnt(0)
    s_mov_b64 exec, 1
    ds_add_u32 v2, v3 offset:60
    s_mov_b64 exec, -1
    v_lshlrev_b32 v32, 16, v16
    v_and_b32 v33, 0xffff0000, v16
    v_lshlrev_b32 v34, 16, v112
    v_and_b32 v35, 0xffff0000, v112
    v_pk_mul_f32 v[32:33], v[32:33], v[34:35]
    v_cvt_pk_bf16_f32 v16, v32, v33
    v_lshlrev_b32 v32, 16, v17
    v_and_b32 v33, 0xffff0000, v17
    v_lshlrev_b32 v34, 16, v113
    v_and_b32 v35, 0xffff0000, v113
    v_pk_mul_f32 v[32:33], v[32:33], v[34:35]
    v_cvt_pk_bf16_f32 v17, v32, v33
    v_lshlrev_b32 v32, 16, v18
    v_and_b32 v33, 0xffff0000, v18
    v_lshlrev_b32 v34, 16, v114
    v_and_b32 v35, 0xffff0000, v114
    v_pk_mul_f32 v[32:33], v[32:33], v[34:35]
    v_cvt_pk_bf16_f32 v18, v32, v33
    v_lshlrev_b32 v32, 16, v19
    v_and_b32 v33, 0xffff0000, v19
    v_lshlrev_b32 v34, 16, v115
    v_and_b32 v35, 0xffff0000, v115
    v_pk_mul_f32 v[32:33], v[32:33], v[34:35]
    v_cvt_pk_bf16_f32 v19, v32, v33
    v_lshlrev_b32 v32, 16, v20
    v_and_b32 v33, 0xffff0000, v20
    v_lshlrev_b32 v34, 16, v116
    v_and_b32 v35, 0xffff0000, v116
    v_pk_mul_f32 v[32:33], v[32:33], v[34:35]
    v_cvt_pk_bf16_f32 v20, v32, v33
    v_lshlrev_b32 v32, 16, v21
    v_and_b32 v33, 0xffff0000, v21
    v_lshlrev_b32 v34, 16, v117
    v_and_b32 v35, 0xffff0000, v117
    v_pk_mul_f32 v[32:33], v[32:33], v[34:35]
    v_cvt_pk_bf16_f32 v21, v32, v33
    v_lshlrev_b32 v32, 16, v22
    v_and_b32 v33, 0xffff0000, v22
    v_lshlrev_b32 v34, 16, v118
    v_and_b32 v35, 0xffff0000, v118
    v_pk_mul_f32 v[32:33], v[32:33], v[34:35]
    v_cvt_pk_bf16_f32 v22, v32, v33
    v_lshlrev_b32 v32, 16, v23
    v_and_b32 v33, 0xffff0000, v23
    v_lshlrev_b32 v34, 16, v119
    v_and_b32 v35, 0xffff0000, v119
    v_pk_mul_f32 v[32:33], v[32:33], v[34:35]
    v_cvt_pk_bf16_f32 v23, v32, v33
    v_lshlrev_b32 v32, 16, v24
    v_and_b32 v33, 0xffff0000, v24
    v_lshlrev_b32 v34, 16, v120
    v_and_b32 v35, 0xffff0000, v120
    v_pk_mul_f32 v[32:33], v[32:33], v[34:35]
    v_cvt_pk_bf16_f32 v24, v32, v33
    v_lshlrev_b32 v32, 16, v25
    v_and_b32 v33, 0xffff0000, v25
    v_lshlrev_b32 v34, 16, v121
    v_and_b32 v35, 0xffff0000, v121
    v_pk_mul_f32 v[32:33], v[32:33], v[34:35]
    v_cvt_pk_bf16_f32 v25, v32, v33
    v_lshlrev_b32 v32, 16, v26
    v_and_b32 v33, 0xffff0000, v26
    v_lshlrev_b32 v34, 16, v122
    v_and_b32 v35, 0xffff0000, v122
    v_pk_mul_f32 v[32:33], v[32:33], v[34:35]
    v_cvt_pk_bf16_f32 v26, v32, v33
    v_lshlrev_b32 v32, 16, v27
    v_and_b32 v33, 0xffff0000, v27
    v_lshlrev_b32 v34, 16, v123
    v_and_b32 v35, 0xffff0000, v123
    v_pk_mul_f32 v[32:33], v[32:33], v[34:35]
    v_cvt_pk_bf16_f32 v27, v32, v33
    buffer_store_dwordx4 v[16:19], v124, s[32:35], s76 offen offset:0
    buffer_store_dwordx4 v[20:23], v124, s[32:35], s76 offen offset:16
    buffer_store_dwordx4 v[24:27], v124, s[32:35], s76 offen offset:32
    s_branch L_oproj
L_b_end:
    s_endpgm
L_exit:
    s_endpgm
.section .rodata,"a"
.p2align 6
.amdhsa_kernel concat_heads__grouped_kv_mqa__ssm_conv_h3__prompt_kernel
  .amdhsa_next_free_vgpr 128
  .amdhsa_next_free_sgpr 102
  .amdhsa_accum_offset 128
  .amdhsa_group_segment_fixed_size 0
  .amdhsa_kernarg_size 112
  .amdhsa_user_sgpr_count 2
  .amdhsa_user_sgpr_kernarg_segment_ptr 1
  .amdhsa_system_sgpr_workgroup_id_x 1
.end_amdhsa_kernel
```
